```python
import torch

def _softmax(x, axis=-1):
    return torch.softmax(x, dim=axis)
def _gelu(x):
    return torch.nn.functional.gelu(x, approximate="tanh")
def _silu(x):
    return torch.nn.functional.silu(x)
def _sigmoid(x):
    return torch.sigmoid(x)
def _layernorm(x, axis=-1, eps=1e-5):
    m = x.mean(dim=axis, keepdim=True)
    v = x.var(dim=axis, keepdim=True, unbiased=False)
    return (x - m) / torch.sqrt(v + eps)
def _scatter_add(tgt, idx, src, axis=0):
    return tgt.clone().index_add_(axis, idx, src)
def _segment_sum(src, seg, n):
    out = torch.zeros((n,) + src.shape[1:], dtype=src.dtype)
    return out.index_add_(0, seg, src)
def _pad(x, pw):
    flat = tuple(v for pair in reversed(pw) for v in pair)
    return torch.nn.functional.pad(x, flat)

kernel_name = 'sequential_preLN__ssm_conv_s4__dense_activation_gelu__prompt'

def setup_inputs():

    _w = (lambda a: (lambda t: t.to(torch.bfloat16) if t.is_floating_point() else t)(torch.as_tensor(a)))
    def _A_setup():
        B, L, D, N = 1, 2048, 640, 192
        A_re = -(lambda _x: torch.exp(torch.as_tensor(_x)))((lambda *s: torch.randn(*s, dtype=torch.bfloat16) * 6.4)(D, N))
        A_im = torch.pi * (lambda *s: torch.randn(*s, dtype=torch.bfloat16) * 0.05)(D, N)
        B_re = (lambda *s: torch.randn(*s, dtype=torch.bfloat16) * 0.05)(D, N)
        B_im = (lambda *s: torch.randn(*s, dtype=torch.bfloat16) * 0.05)(D, N)
        C_re = (lambda *s: torch.randn(*s, dtype=torch.bfloat16) * 0.05)(D, N)
        C_im = (lambda *s: torch.randn(*s, dtype=torch.bfloat16) * 0.05)(D, N)
        log_dt = (lambda *s: torch.randn(*s, dtype=torch.bfloat16) * 0.05)(D) * 0.5 - 4.0
        Dskip = (lambda *s: torch.randn(*s, dtype=torch.bfloat16) * 0.05)(D)
        return {
            "u": _w((lambda *s: torch.randn(*s, dtype=torch.bfloat16) * 0.05)(B, L, D)),
            "A_re": _w(A_re),
            "A_im": _w(A_im),
            "B_re": _w(B_re),
            "B_im": _w(B_im),
            "C_re": _w(C_re),
            "C_im": _w(C_im),
            "log_dt": _w(log_dt),
            "Dskip": _w(Dskip),
        }
    _A_in = _A_setup()

    def _B_setup():
        B, S, D, F = 1, 2048, 640, 1536
        return {
            "x": _w((lambda *s: torch.randn(*s, dtype=torch.bfloat16) * 0.05)(B, S, D)),
            "w1": _w((lambda *s: torch.randn(*s, dtype=torch.bfloat16) * 0.8)(D, F) * (D ** -0.5)),
            "b1": _w((lambda *s: torch.randn(*s, dtype=torch.bfloat16) * 12.8)(F) * 0.01),
            "w2": _w((lambda *s: torch.randn(*s, dtype=torch.bfloat16) * 0.4)(F, D) * (F ** -0.5)),
            "b2": _w((lambda *s: torch.randn(*s, dtype=torch.bfloat16) * 6.4)(D) * 0.01),
        }
    _B_in = _B_setup()

    return {
        "A_u": _A_in["u"],
        "A_A_re": _A_in["A_re"],
        "A_A_im": _A_in["A_im"],
        "A_B_re": _A_in["B_re"],
        "A_B_im": _A_in["B_im"],
        "A_C_re": _A_in["C_re"],
        "A_C_im": _A_in["C_im"],
        "A_log_dt": _A_in["log_dt"],
        "A_Dskip": _A_in["Dskip"],
        "B_x": _B_in["x"],
        "B_w1": _B_in["w1"],
        "B_b1": _B_in["b1"],
        "B_w2": _B_in["w2"],
        "B_b2": _B_in["b2"],
    }

def reference(A_u, A_A_re, A_A_im, A_B_re, A_B_im, A_C_re, A_C_im, A_log_dt, A_Dskip, B_x, B_w1, B_b1, B_w2, B_b2):
    def _A_ref(u, A_re, A_im, B_re, B_im, C_re, C_im, log_dt, Dskip):
        Bsz, L, D = u.shape
        dt = torch.exp(log_dt)[:, None]
        A = A_re + 1j * A_im
        Bc = B_re + 1j * B_im
        Cc = C_re + 1j * C_im
        logdA = dt * A
        dB = dt * Bc
        l = (lambda x, dt: x.to(dt))(torch.arange(L), A_re.dtype)
        P = torch.exp(logdA[:, :, None] * l[None, None, :])
        K = torch.einsum("dn,dnl,dn->dl", Cc, P, dB).real
        L2 = 2 * L
        Kp = _pad(K, ((0, 0), (0, L)))
        up = (lambda x, *d: x.permute(*d))(u, 0, 2, 1)
        up = _pad(up, ((0, 0), (0, 0), (0, L)))
        Kf = (lambda x, axes=(-2,-1): torch.fft.rfft2(x.float(), dim=axes))(Kp[:, None, :], axes=(-2, -1))
        Uf = (lambda x, axes=(-2,-1): torch.fft.rfft2(x.float(), dim=axes))(up[:, :, None, :], axes=(-2, -1))
        Yf = Uf * Kf[None, :, :, :]
        y = (lambda x, s, axes=(-2,-1): torch.fft.irfft2(x, s=s, dim=axes).to(torch.bfloat16))(Yf, (1, L2), axes=(-2, -1))[:, :, 0, :L]
        y = (lambda x, *d: x.permute(*d))(y, 0, 2, 1) + u * Dskip[None, None, :]
        return y

    def _B_ref(x, w1, b1, w2, b2):
        h = torch.einsum("bsd,df->bsf", x, w1) + b1
        h = _gelu(h)
        return torch.einsum("bsf,fd->bsd", h, w2) + b2

    x = A_u
    h = x + _A_ref(_layernorm(x, axis=-1), A_A_re, A_A_im, A_B_re, A_B_im, A_C_re, A_C_im, A_log_dt, A_Dskip)
    h2 = h + _B_ref(_layernorm(h, axis=-1), B_w1, B_b1, B_w2, B_b2)
    return h2
```

```asm
; @launch grid=(256,1,1) block=(256,1,1) lds=163840
.amdgcn_target "amdgcn-amd-amdhsa--gfx950"
.text
.globl sequential_preLN__ssm_conv_s4__dense_activation_gelu__prompt_kernel
.p2align 8
.type sequential_preLN__ssm_conv_s4__dense_activation_gelu__prompt_kernel,@function
sequential_preLN__ssm_conv_s4__dense_activation_gelu__prompt_kernel:
s_cmp_ge_u32 s2, 256
s_cbranch_scc1 L_exit
s_load_dwordx16 s[8:23], s[0:1], 0
s_load_dwordx16 s[24:39], s[0:1], 64
s_load_dwordx2 s[40:41], s[0:1], 128
s_getpc_b64 s[68:69]
L_pf_base:
v_lshlrev_b32 v1, 4, v0
s_add_u32 s4, s68, L_table-L_pf_base
s_addc_u32 s5, s69, 0
s_lshr_b32 s61, s2, 3
s_lshl_b32 s62, s61, 11
v_lshrrev_b32 v4, 3, v0
v_lshl_add_u32 v4, v4, 6, s62
v_min_u32 v4, L_table_end-L_pf_base-4, v4
global_load_dword v61, v4, s[68:69]
v_lshrrev_b32 v4, 6, v0
v_and_b32 v5, 63, v0
v_readfirstlane_b32 s3, v4
v_lshlrev_b32 v2, 4, v5
s_and_b32 s60, s2, 7
s_lshl_b32 s43, s60, 4
s_lshr_b32 s62, s2, 4
s_add_u32 s43, s43, s62
s_and_b32 s44, s61, 1
s_mul_i32 s47, s43, 5
s_mul_i32 s62, s44, 3
s_add_u32 s7, s47, 2
s_add_u32 s47, s47, s62
s_lshl_b32 s65, s47, 1
v_mov_b32 v11, s65
s_lshl_b32 s65, s7, 1
v_mov_b32 v62, s65
s_cmp_eq_u32 s3, 3
s_cbranch_scc1 L1_svc0
s_add_u32 s64, s47, s3
s_cmp_eq_u32 s3, 2
s_cselect_b32 s64, s7, s64
s_mul_i32 s65, s64, 384
v_mul_u32_u24 v4, 6, v5
v_and_b32 v4, -4, v4
v_add_u32 v4, s65, v4
v_and_b32 v201, 1, v5
s_lshl_b32 s65, s64, 1
v_mov_b32 v5, s65
v_mul_u32_u24 v201, 0x0202, v201
v_lshlrev_b32 v201, 16, v201
v_add_u32 v201, 0x01000c0c, v201
s_mul_i32 s65, s3, 15968
s_mov_b32 m0, s65
v_mov_b32 v176, 0x3f80
v_mov_b64 v[160:161], 0
v_mov_b64 v[162:163], 0
v_mov_b64 v[164:165], 0
v_mov_b64 v[166:167], 0
v_mov_b64 v[168:169], 0
v_mov_b64 v[170:171], 0
v_mov_b64 v[172:173], 0
v_mov_b64 v[174:175], 0
s_waitcnt lgkmcnt(0)
global_load_ushort v200, v5, s[22:23]
global_load_dwordx2 v[184:185], v4, s[10:11]
global_load_dwordx2 v[186:187], v4, s[12:13]
global_load_dwordx2 v[188:189], v4, s[14:15]
global_load_dwordx2 v[190:191], v4, s[16:17]
global_load_dwordx2 v[192:193], v4, s[18:19]
global_load_dwordx2 v[194:195], v4, s[20:21]
global_load_ushort v10, v11, s[24:25]
global_load_ushort v11, v11, s[24:25] offset:2
global_load_ushort v62, v62, s[24:25]
s_load_dword s42, s[40:41], 0
ds_write_addtid_b32 v176 offset:0
s_and_b32 s45, s61, 7
s_and_b32 s65, s60, 0
s_lshl_b32 s65, s65, 3
s_add_u32 s45, s45, s65
s_lshr_b32 s72, s61, 3
s_lshr_b32 s46, s60, 0
s_lshl_b32 s46, s46, 2
s_add_u32 s46, s46, s72
s_mul_i32 s65, s43, 32896
s_add_u32 s65, s65, 1052672
s_add_u32 s48, s40, s65
s_addc_u32 s49, s41, 0
s_lshl_b32 s65, s47, 6
s_add_u32 s65, s65, 6291456
s_add_u32 s50, s40, s65
s_addc_u32 s51, s41, 0
s_lshl_b32 s65, s7, 6
s_mul_i32 s66, s44, 163840
s_add_u32 s65, s65, s66
s_add_u32 s65, s65, 6291456
s_add_u32 s52, s40, s65
s_addc_u32 s53, s41, 0
s_mul_i32 s65, s46, 40960
s_add_u32 s65, s65, 6291456
s_add_u32 s54, s40, s65
s_addc_u32 s55, s41, 0
s_add_u32 s58, s40, 4096
s_addc_u32 s59, s41, 0
v_add_u32 v9, 8192, v2
v_lshrrev_b32 v60, 8, v2
s_mul_i32 s65, s45, 384
s_lshl_b32 s66, s3, 6
s_add_u32 s66, s66, s65
v_lshl_add_u32 v48, v60, 4, s66
s_lshl_b32 s66, s3, 5
s_add_u32 s66, s66, s65
v_and_b32 v52, 1, v60
v_lshl_add_u32 v52, v52, 4, s66
v_lshrrev_b32 v53, 1, v60
v_lshl_add_u32 v52, v53, 3, v52
s_mul_i32 s65, s45, 160
s_and_b32 s66, s3, 1
s_lshl_b32 s66, s66, 6
s_add_u32 s66, s66, s65
v_lshl_add_u32 v54, v60, 4, s66
v_lshl_add_u32 v58, v60, 3, s65
v_lshrrev_b32 v64, 4, v2
v_and_b32 v65, 0x30, v64
v_and_b32 v66, 15, v64
v_and_b32 v67, 1, v64
v_bfe_u32 v68, v64, 1, 3
v_and_b32 v69, 3, v64
v_bfe_u32 v70, v64, 2, 2
s_lshr_b32 s65, s3, 1
s_and_b32 s66, s3, 1
v_mov_b32 v76, 0
v_mov_b32 v77, 0
v_mov_b32 v78, 0
v_mov_b32 v79, 0
s_mul_i32 s67, s3, 4640
s_add_u32 s67, s67, 97824
v_add_u32 v71, s67, v2
ds_write_b128 v71, v[76:79]
s_mul_i32 s67, s65, 5152
s_lshl_b32 s68, s66, 10
s_add_u32 s67, s67, s68
s_add_u32 s67, s67, 116384
v_add_u32 v71, s67, v2
ds_write_b128 v71, v[76:79]
v_lshrrev_b32 v71, 3, v0
v_min_u32 v71, 11, v71
v_mul_u32_u24 v71, 4160, v71
v_and_b32 v72, 7, v64
v_mul_u32_u24 v15, 37, v72
v_min_u32 v72, 4, v72
v_lshl_add_u32 v71, v72, 4, v71
ds_write_b128 v71, v[76:79] offset:51984
v_min_u32 v71, 19, v64
v_lshlrev_b32 v14, 10, v71
s_mul_i32 s67, s3, 15968
v_mov_b32 v71, s67
ds_write_b128 v71, v[76:79] offset:15952
v_and_b32 v71, 31, v64
v_lshrrev_b32 v72, 5, v64
v_mul_u32_u24 v16, 272, v71
v_lshl_add_u32 v16, v72, 4, v16
v_add_u32 v16, s67, v16
s_add_u32 s67, s67, 14416
v_lshl_add_u32 v17, v71, 4, s67
v_lshl_add_u32 v17, v72, 3, v17
v_lshl_add_u32 v20, v72, 8, s67
v_sub_u32 v73, 3, v72
v_lshlrev_b32 v73, v73, v71
v_add_u32 v18, 512, v20
v_add_u32 v18, v73, v18
v_mul_u32_u24 v73, 124, v72
v_add3_u32 v19, v18, v73, 4
v_lshl_add_u32 v20, v71, 1, v20
s_lshl_b32 s67, s3, 9
v_lshl_add_u32 v71, v64, 1, s67
s_mov_b32 s68, 4294933248
v_sub_u32 v72, 2047, v71
v_sub_u32 v73, 2046, v71
v_cvt_f32_i32 v24, v72
v_cvt_f32_i32 v25, v73
v_cvt_pk_bf16_f32 v25, v24, v25
v_and_b32 v24, 0xffff, v25
v_lshrrev_b32 v25, 16, v25
v_lshl_add_u32 v24, v24, 1, s68
v_lshl_add_u32 v25, v25, 1, s68
v_sub_u32 v72, 2045, v71
v_sub_u32 v73, 1919, v71
v_cvt_f32_i32 v26, v72
v_cvt_f32_i32 v27, v73
v_cvt_pk_bf16_f32 v27, v26, v27
v_and_b32 v26, 0xffff, v27
v_lshrrev_b32 v27, 16, v27
v_lshl_add_u32 v26, v26, 1, s68
v_lshl_add_u32 v27, v27, 1, s68
v_sub_u32 v72, 1918, v71
v_sub_u32 v73, 1917, v71
v_cvt_f32_i32 v28, v72
v_cvt_f32_i32 v29, v73
v_cvt_pk_bf16_f32 v29, v28, v29
v_and_b32 v28, 0xffff, v29
v_lshrrev_b32 v29, 16, v29
v_lshl_add_u32 v28, v28, 1, s68
v_lshl_add_u32 v29, v29, 1, s68
v_sub_u32 v72, 1791, v71
v_sub_u32 v73, 1790, v71
v_cvt_f32_i32 v30, v72
v_cvt_f32_i32 v31, v73
v_cvt_pk_bf16_f32 v31, v30, v31
v_and_b32 v30, 0xffff, v31
v_lshrrev_b32 v31, 16, v31
v_lshl_add_u32 v30, v30, 1, s68
v_lshl_add_u32 v31, v31, 1, s68
v_sub_u32 v72, 1789, v71
v_sub_u32 v73, 1663, v71
v_cvt_f32_i32 v32, v72
v_cvt_f32_i32 v33, v73
v_cvt_pk_bf16_f32 v33, v32, v33
v_and_b32 v32, 0xffff, v33
v_lshrrev_b32 v33, 16, v33
v_lshl_add_u32 v32, v32, 1, s68
v_lshl_add_u32 v33, v33, 1, s68
v_cmp_gt_i32 vcc, 128, v72
v_lshlrev_b32 v72, 1, v72
s_nop 0
v_cndmask_b32 v32, v32, v72, vcc
v_cmp_gt_i32 vcc, 128, v73
v_lshlrev_b32 v73, 1, v73
s_nop 0
v_cndmask_b32 v33, v33, v73, vcc
v_sub_u32 v72, 1662, v71
v_sub_u32 v73, 1661, v71
v_cvt_f32_i32 v34, v72
v_cvt_f32_i32 v35, v73
v_cvt_pk_bf16_f32 v35, v34, v35
v_and_b32 v34, 0xffff, v35
v_lshrrev_b32 v35, 16, v35
v_lshl_add_u32 v34, v34, 1, s68
v_lshl_add_u32 v35, v35, 1, s68
v_cmp_gt_i32 vcc, 128, v72
v_lshlrev_b32 v72, 1, v72
s_nop 0
v_cndmask_b32 v34, v34, v72, vcc
v_cmp_gt_i32 vcc, 128, v73
v_lshlrev_b32 v73, 1, v73
s_nop 0
v_cndmask_b32 v35, v35, v73, vcc
v_min_u32 v35, 1536, v35
v_sub_u32 v71, 3, v69
v_mul_u32_u24 v71, 4160, v71
v_lshlrev_b32 v72, 4, v70
v_sub_u32 v72, v65, v72
s_mul_i32 s67, s65, 16640
s_lshl_b32 s68, s66, 8
s_sub_u32 s67, s67, s68
s_add_u32 s67, s67, 48208
v_add3_u32 v36, v71, v72, s67
s_mul_i32 s67, s65, 9280
s_sub_u32 s67, s67, s68
s_add_u32 s67, s67, 98144
s_lshl_b32 s68, s3, 8
s_sub_u32 s68, 82000, s68
v_add3_u32 v37, v71, v72, s68
v_xor_b32 v71, 1, v67
v_mul_u32_u24 v72, 4640, v71
v_lshl_add_u32 v73, v68, 6, v65
v_add3_u32 v38, v72, v73, s67
v_mul_u32_u24 v72, 5152, v71
v_and_b32 v71, 8, v64
v_lshl_add_u32 v73, v71, 5, v73
s_lshl_b32 s68, s3, 8
s_sub_u32 s68, 117216, s68
v_add3_u32 v39, v72, v73, s68
v_mul_u32_u24 v71, 576, v67
v_lshl_add_u32 v71, v68, 4, v71
v_lshl_add_u32 v71, v65, 3, v71
s_mul_i32 s67, s3, 6528
s_add_u32 s67, s67, 126688
v_add_u32 v40, s67, v71
s_mul_i32 s67, s3, 2176
s_add_u32 s67, s67, 152800
v_add_u32 v41, s67, v71
v_lshrrev_b32 v71, 5, v64
s_lshl_b32 s67, s3, 9
s_add_u32 s67, s67, 97824
v_mul_u32_u24 v72, 1536, v71
v_add3_u32 v42, v72, v2, s67
v_bfe_u32 v72, v64, 2, 3
v_mul_u32_u24 v73, 13056, v71
v_lshl_add_u32 v73, v72, 4, v73
v_lshl_add_u32 v73, v69, 7, v73
s_mul_i32 s67, s3, 1088
s_add_u32 s67, s67, 126688
v_add_u32 v43, s67, v73
s_mul_i32 s67, s3, 327680
v_mul_u32_u24 v73, 40960, v72
v_lshl_add_u32 v73, v71, 6, v73
v_lshlrev_b32 v71, 4, v69
v_add3_u32 v46, v73, v71, s67
v_mul_u32_u24 v73, 40960, v70
v_add3_u32 v47, v73, v71, s67
v_lshlrev_b32 v71, 4, v70
v_lshl_add_u32 v71, v69, 7, v71
s_mul_i32 s67, s65, 1088
s_lshl_b32 s68, s66, 6
s_add_u32 s67, s67, s68
s_add_u32 s68, s67, 131040
v_mul_u32_u24 v72, 408, v65
v_add3_u32 v44, v71, v72, s68
s_add_u32 s68, s67, 152800
v_mul_u32_u24 v72, 136, v65
v_add3_u32 v45, v71, v72, s68
v_mov_b32 v6, 0
s_lshl_b32 s65, s45, 2
s_add_u32 s65, s65, s3
s_mul_i32 s65, s65, 61440
s_add_u32 s65, s65, 9441280
s_add_u32 s84, s40, s65
s_addc_u32 s85, s41, 0
s_add_u32 s86, s84, 15360
s_addc_u32 s87, s85, 0
s_add_u32 s88, s84, 30720
s_addc_u32 s89, s85, 0
s_add_u32 s90, s84, 46080
s_addc_u32 s91, s85, 0
s_lshl_b32 s65, s44, 4
s_lshl_b32 s82, 0xffff, s65
s_mov_b32 s83, 0
s_mov_b32 s80, 0
s_mov_b32 s81, s82
s_mul_i32 s60, s3, 10240
s_min_u32 s65, s2, 191
s_mul_i32 s66, s65, 10240
s_add_u32 s32, s32, s66
s_addc_u32 s33, s33, 0
s_lshr_b32 s66, s65, 2
s_mul_i32 s66, s66, 5120
s_and_b32 s65, s65, 3
s_lshl_b32 s65, s65, 8
s_add_u32 s65, s65, s66
s_add_u32 s65, s65, 11534336
s_add_u32 s28, s40, s65
s_addc_u32 s29, s41, 0
s_cmp_lt_u32 s2, 192
s_cselect_b64 s[76:77], -1, 0
s_lshl_b32 s63, s3, 10
s_and_b32 s64, s63, 1024
s_lshl_b32 s65, s2, 7
s_lshl_b32 s66, s3, 2
s_add_u32 s65, s65, s66
s_add_u32 s65, s65, 131072
s_add_u32 s18, s40, s65
s_addc_u32 s19, s41, 0
s_and_b32 s7, s43, 1
s_lshl_b32 s7, s7, 1
s_add_u32 s7, s7, s44
s_mov_b32 s38, 0x3f80
s_mov_b32 s39, 0x3f800000
s_mov_b32 s6, 0
s_waitcnt vmcnt(7)
v_lshlrev_b32 v200, 16, v200
v_mul_f32 v200, 0x3fb8aa3b, v200
v_exp_f32 v200, v200
s_nop 0
v_cvt_pk_bf16_f32 v200, v200, v200
v_lshlrev_b32 v244, 16, v200
v_mul_f32 v242, 0x3fb8aa3b, v244
v_mul_f32 v243, 0.15915494, v244
v_perm_b32 v232, v185, v184, v201
v_perm_b32 v233, v187, v186, v201
v_mul_f32 v232, v232, v242
v_mul_f32 v233, v233, v243
v_exp_f32 v234, v232
v_rndne_f32 v235, v233
v_mul_f32 v238, 0x43800000, v232
v_sub_f32 v235, v233, v235
v_mul_f32 v239, 0x43800000, v233
v_cos_f32 v236, v235
v_fract_f32 v239, v239
v_sin_f32 v237, v235
v_exp_f32 v238, v238
v_cos_f32 v240, v239
v_sin_f32 v241, v239
v_mul_f32 v202, v234, v236
v_mul_f32 v203, v234, v237
v_mul_f32 v214, v238, v240
v_mul_f32 v215, v238, v241
L3_kloop:
v_cvt_pk_bf16_f32 v176, v202, v203
v_pk_mul_f32 v[228:229], v[202:203], v[202:203] op_sel_hi:[0,1]
v_pk_fma_f32 v[204:205], v[202:203], v[202:203], v[228:229] op_sel:[1,1,0] op_sel_hi:[1,0,1] neg_lo:[0,1,0]
v_cvt_pk_bf16_f32 v177, v204, v205
v_pk_mul_f32 v[228:229], v[204:205], v[202:203] op_sel_hi:[0,1]
v_pk_fma_f32 v[206:207], v[204:205], v[202:203], v[228:229] op_sel:[1,1,0] op_sel_hi:[1,0,1] neg_lo:[0,1,0]
v_cvt_pk_bf16_f32 v178, v206, v207
v_pk_mul_f32 v[228:229], v[204:205], v[204:205] op_sel_hi:[0,1]
v_pk_fma_f32 v[208:209], v[204:205], v[204:205], v[228:229] op_sel:[1,1,0] op_sel_hi:[1,0,1] neg_lo:[0,1,0]
v_cvt_pk_bf16_f32 v179, v208, v209
v_pk_mul_f32 v[228:229], v[208:209], v[202:203] op_sel_hi:[0,1]
v_pk_fma_f32 v[230:231], v[208:209], v[202:203], v[228:229] op_sel:[1,1,0] op_sel_hi:[1,0,1] neg_lo:[0,1,0]
v_cvt_pk_bf16_f32 v180, v230, v231
v_pk_mul_f32 v[228:229], v[208:209], v[204:205] op_sel_hi:[0,1]
v_pk_fma_f32 v[210:211], v[208:209], v[204:205], v[228:229] op_sel:[1,1,0] op_sel_hi:[1,0,1] neg_lo:[0,1,0]
v_cvt_pk_bf16_f32 v181, v210, v211
v_pk_mul_f32 v[228:229], v[208:209], v[206:207] op_sel_hi:[0,1]
v_pk_fma_f32 v[230:231], v[208:209], v[206:207], v[228:229] op_sel:[1,1,0] op_sel_hi:[1,0,1] neg_lo:[0,1,0]
v_cvt_pk_bf16_f32 v182, v230, v231
v_pk_mul_f32 v[228:229], v[208:209], v[208:209] op_sel_hi:[0,1]
v_pk_fma_f32 v[212:213], v[208:209], v[208:209], v[228:229] op_sel:[1,1,0] op_sel_hi:[1,0,1] neg_lo:[0,1,0]
v_cvt_pk_bf16_f32 v183, v214, v215
s_cmp_eq_u32 s6, 0
s_cbranch_scc1 L4_k0
s_waitcnt lgkmcnt(0)
v_mfma_f32_32x32x16_bf16 v[160:175], v[96:99], v[100:103], v[160:175]
ds_write_addtid_b32 v176 offset:272
ds_write_addtid_b32 v177 offset:544
ds_write_addtid_b32 v178 offset:816
ds_write_addtid_b32 v179 offset:1088
ds_write_addtid_b32 v180 offset:1360
v_mfma_f32_32x32x16_bf16 v[160:175], v[104:107], v[108:111], v[160:175]
ds_write_addtid_b32 v181 offset:1632
ds_write_addtid_b32 v182 offset:1904
ds_write_addtid_b32 v183 offset:2176
v_perm_b32 v196, v189, v188, v201
v_perm_b32 v197, v191, v190, v201
v_mfma_f32_32x32x16_bf16 v[160:175], v[112:115], v[116:119], v[160:175]
v_perm_b32 v198, v193, v192, v201
v_perm_b32 v199, v195, v194, v201
v_add_u32 v201, 0x02020000, v201
v_perm_b32 v232, v185, v184, v201
v_perm_b32 v233, v187, v186, v201
v_mfma_f32_32x32x16_bf16 v[160:175], v[120:123], v[124:127], v[160:175]
v_mul_f32 v232, v232, v242
v_mul_f32 v233, v233, v243
v_exp_f32 v234, v232
v_rndne_f32 v235, v233
v_mfma_f32_32x32x16_bf16 v[160:175], v[128:131], v[132:135], v[160:175]
v_mul_f32 v238, 0x43800000, v232
v_sub_f32 v235, v233, v235
v_mul_f32 v239, 0x43800000, v233
v_cos_f32 v236, v235
v_mfma_f32_32x32x16_bf16 v[160:175], v[136:139], v[140:143], v[160:175]
v_fract_f32 v239, v239
v_sin_f32 v237, v235
v_exp_f32 v238, v238
v_mfma_f32_32x32x16_bf16 v[160:175], v[144:147], v[148:151], v[160:175]
v_cos_f32 v240, v239
v_sin_f32 v241, v239
v_mul_f32 v222, v234, v236
v_mfma_f32_32x32x16_bf16 v[160:175], v[152:155], v[156:159], v[160:175]
v_mul_f32 v223, v234, v237
v_mul_f32 v224, v238, v240
v_mul_f32 v225, v238, v241
L5_k1:
v_pk_mul_f32 v[228:229], v[214:215], v[204:205] op_sel_hi:[0,1]
v_pk_fma_f32 v[230:231], v[214:215], v[204:205], v[228:229] op_sel:[1,1,0] op_sel_hi:[1,0,1] neg_lo:[0,1,0]
v_cvt_pk_bf16_f32 v176, v230, v231
v_pk_mul_f32 v[228:229], v[214:215], v[208:209] op_sel_hi:[0,1]
v_pk_fma_f32 v[230:231], v[214:215], v[208:209], v[228:229] op_sel:[1,1,0] op_sel_hi:[1,0,1] neg_lo:[0,1,0]
v_cvt_pk_bf16_f32 v177, v230, v231
v_pk_mul_f32 v[228:229], v[214:215], v[210:211] op_sel_hi:[0,1]
v_pk_fma_f32 v[230:231], v[214:215], v[210:211], v[228:229] op_sel:[1,1,0] op_sel_hi:[1,0,1] neg_lo:[0,1,0]
v_cvt_pk_bf16_f32 v178, v230, v231
v_pk_mul_f32 v[228:229], v[214:215], v[214:215] op_sel_hi:[0,1]
v_pk_fma_f32 v[216:217], v[214:215], v[214:215], v[228:229] op_sel:[1,1,0] op_sel_hi:[1,0,1] neg_lo:[0,1,0]
v_cvt_pk_bf16_f32 v179, v216, v217
v_pk_mul_f32 v[228:229], v[216:217], v[208:209] op_sel_hi:[0,1]
v_pk_fma_f32 v[230:231], v[216:217], v[208:209], v[228:229] op_sel:[1,1,0] op_sel_hi:[1,0,1] neg_lo:[0,1,0]
v_cvt_pk_bf16_f32 v180, v230, v231
v_pk_mul_f32 v[228:229], v[216:217], v[214:215] op_sel_hi:[0,1]
v_pk_fma_f32 v[218:219], v[216:217], v[214:215], v[228:229] op_sel:[1,1,0] op_sel_hi:[1,0,1] neg_lo:[0,1,0]
v_cvt_pk_bf16_f32 v181, v218, v219
v_pk_mul_f32 v[228:229], v[218:219], v[208:209] op_sel_hi:[0,1]
v_pk_fma_f32 v[230:231], v[218:219], v[208:209], v[228:229] op_sel:[1,1,0] op_sel_hi:[1,0,1] neg_lo:[0,1,0]
v_cvt_pk_bf16_f32 v182, v230, v231
v_pk_mul_f32 v[228:229], v[216:217], v[216:217] op_sel_hi:[0,1]
v_pk_fma_f32 v[220:221], v[216:217], v[216:217], v[228:229] op_sel:[1,1,0] op_sel_hi:[1,0,1] neg_lo:[0,1,0]
v_cvt_pk_bf16_f32 v183, v220, v221
ds_write_addtid_b32 v176 offset:2448
ds_write_addtid_b32 v177 offset:2720
ds_write_addtid_b32 v178 offset:2992
ds_write_addtid_b32 v179 offset:3264
ds_write_addtid_b32 v180 offset:3536
ds_write_addtid_b32 v181 offset:3808
ds_write_addtid_b32 v182 offset:4080
ds_write_addtid_b32 v183 offset:4352
v_pk_mul_f32 v[228:229], v[220:221], v[214:215] op_sel_hi:[0,1]
v_pk_fma_f32 v[230:231], v[220:221], v[214:215], v[228:229] op_sel:[1,1,0] op_sel_hi:[1,0,1] neg_lo:[0,1,0]
v_cvt_pk_bf16_f32 v176, v230, v231
v_pk_mul_f32 v[228:229], v[220:221], v[216:217] op_sel_hi:[0,1]
v_pk_fma_f32 v[230:231], v[220:221], v[216:217], v[228:229] op_sel:[1,1,0] op_sel_hi:[1,0,1] neg_lo:[0,1,0]
v_cvt_pk_bf16_f32 v177, v230, v231
v_pk_mul_f32 v[228:229], v[220:221], v[218:219] op_sel_hi:[0,1]
v_pk_fma_f32 v[230:231], v[220:221], v[218:219], v[228:229] op_sel:[1,1,0] op_sel_hi:[1,0,1] neg_lo:[0,1,0]
v_cvt_pk_bf16_f32 v178, v230, v231
v_pk_mul_f32 v[228:229], v[220:221], v[220:221] op_sel_hi:[0,1]
v_pk_fma_f32 v[230:231], v[220:221], v[220:221], v[228:229] op_sel:[1,1,0] op_sel_hi:[1,0,1] neg_lo:[0,1,0]
v_cvt_pk_bf16_f32 v179, v230, v231
v_pk_mul_f32 v[228:229], v[198:199], v[196:197] op_sel_hi:[0,1]
v_pk_fma_f32 v[226:227], v[198:199], v[196:197], v[228:229] op_sel:[1,1,0] op_sel_hi:[1,0,1] neg_lo:[0,1,0]
v_pk_mul_f32 v[226:227], v[226:227], v[244:245] op_sel_hi:[1,0]
v_cvt_pk_bf16_f32 v180, v226, -v227
v_pk_mul_f32 v[228:229], v[226:227], v[212:213] op_sel_hi:[0,1]
v_pk_fma_f32 v[226:227], v[226:227], v[212:213], v[228:229] op_sel:[1,1,0] op_sel_hi:[1,0,1] neg_lo:[0,1,0]
v_cvt_pk_bf16_f32 v181, v226, -v227
v_pk_mul_f32 v[228:229], v[226:227], v[212:213] op_sel_hi:[0,1]
v_pk_fma_f32 v[226:227], v[226:227], v[212:213], v[228:229] op_sel:[1,1,0] op_sel_hi:[1,0,1] neg_lo:[0,1,0]
v_cvt_pk_bf16_f32 v182, v226, -v227
v_pk_mul_f32 v[228:229], v[226:227], v[212:213] op_sel_hi:[0,1]
v_pk_fma_f32 v[226:227], v[226:227], v[212:213], v[228:229] op_sel:[1,1,0] op_sel_hi:[1,0,1] neg_lo:[0,1,0]
v_cvt_pk_bf16_f32 v183, v226, -v227
ds_write_addtid_b32 v176 offset:4624
ds_write_addtid_b32 v177 offset:4896
ds_write_addtid_b32 v178 offset:5168
ds_write_addtid_b32 v179 offset:5440
ds_write_addtid_b32 v180 offset:5712
ds_write_addtid_b32 v181 offset:5984
ds_write_addtid_b32 v182 offset:6256
ds_write_addtid_b32 v183 offset:6528
v_pk_mul_f32 v[228:229], v[226:227], v[212:213] op_sel_hi:[0,1]
v_pk_fma_f32 v[226:227], v[226:227], v[212:213], v[228:229] op_sel:[1,1,0] op_sel_hi:[1,0,1] neg_lo:[0,1,0]
v_cvt_pk_bf16_f32 v176, v226, -v227
v_pk_mul_f32 v[228:229], v[226:227], v[212:213] op_sel_hi:[0,1]
v_pk_fma_f32 v[226:227], v[226:227], v[212:213], v[228:229] op_sel:[1,1,0] op_sel_hi:[1,0,1] neg_lo:[0,1,0]
v_cvt_pk_bf16_f32 v177, v226, -v227
v_pk_mul_f32 v[228:229], v[226:227], v[212:213] op_sel_hi:[0,1]
v_pk_fma_f32 v[226:227], v[226:227], v[212:213], v[228:229] op_sel:[1,1,0] op_sel_hi:[1,0,1] neg_lo:[0,1,0]
v_cvt_pk_bf16_f32 v178, v226, -v227
v_pk_mul_f32 v[228:229], v[226:227], v[212:213] op_sel_hi:[0,1]
v_pk_fma_f32 v[226:227], v[226:227], v[212:213], v[228:229] op_sel:[1,1,0] op_sel_hi:[1,0,1] neg_lo:[0,1,0]
v_cvt_pk_bf16_f32 v179, v226, -v227
v_pk_mul_f32 v[228:229], v[226:227], v[212:213] op_sel_hi:[0,1]
v_pk_fma_f32 v[226:227], v[226:227], v[212:213], v[228:229] op_sel:[1,1,0] op_sel_hi:[1,0,1] neg_lo:[0,1,0]
v_cvt_pk_bf16_f32 v180, v226, -v227
v_pk_mul_f32 v[228:229], v[226:227], v[212:213] op_sel_hi:[0,1]
v_pk_fma_f32 v[226:227], v[226:227], v[212:213], v[228:229] op_sel:[1,1,0] op_sel_hi:[1,0,1] neg_lo:[0,1,0]
v_cvt_pk_bf16_f32 v181, v226, -v227
v_pk_mul_f32 v[228:229], v[226:227], v[212:213] op_sel_hi:[0,1]
v_pk_fma_f32 v[226:227], v[226:227], v[212:213], v[228:229] op_sel:[1,1,0] op_sel_hi:[1,0,1] neg_lo:[0,1,0]
v_cvt_pk_bf16_f32 v182, v226, -v227
v_pk_mul_f32 v[228:229], v[226:227], v[212:213] op_sel_hi:[0,1]
v_pk_fma_f32 v[226:227], v[226:227], v[212:213], v[228:229] op_sel:[1,1,0] op_sel_hi:[1,0,1] neg_lo:[0,1,0]
v_cvt_pk_bf16_f32 v183, v226, -v227
ds_write_addtid_b32 v176 offset:6800
ds_write_addtid_b32 v177 offset:7072
ds_write_addtid_b32 v178 offset:7344
ds_write_addtid_b32 v179 offset:7616
ds_write_addtid_b32 v180 offset:7888
ds_write_addtid_b32 v181 offset:8160
ds_write_addtid_b32 v182 offset:8432
ds_write_addtid_b32 v183 offset:8704
v_pk_mul_f32 v[228:229], v[226:227], v[212:213] op_sel_hi:[0,1]
v_pk_fma_f32 v[226:227], v[226:227], v[212:213], v[228:229] op_sel:[1,1,0] op_sel_hi:[1,0,1] neg_lo:[0,1,0]
v_cvt_pk_bf16_f32 v176, v226, -v227
v_pk_mul_f32 v[228:229], v[226:227], v[212:213] op_sel_hi:[0,1]
v_pk_fma_f32 v[226:227], v[226:227], v[212:213], v[228:229] op_sel:[1,1,0] op_sel_hi:[1,0,1] neg_lo:[0,1,0]
v_cvt_pk_bf16_f32 v177, v226, -v227
v_pk_mul_f32 v[228:229], v[226:227], v[212:213] op_sel_hi:[0,1]
v_pk_fma_f32 v[226:227], v[226:227], v[212:213], v[228:229] op_sel:[1,1,0] op_sel_hi:[1,0,1] neg_lo:[0,1,0]
v_cvt_pk_bf16_f32 v178, v226, -v227
v_pk_mul_f32 v[228:229], v[226:227], v[212:213] op_sel_hi:[0,1]
v_pk_fma_f32 v[226:227], v[226:227], v[212:213], v[228:229] op_sel:[1,1,0] op_sel_hi:[1,0,1] neg_lo:[0,1,0]
v_cvt_pk_bf16_f32 v179, v226, -v227
v_pk_mul_f32 v[228:229], v[226:227], v[212:213] op_sel_hi:[0,1]
v_pk_fma_f32 v[226:227], v[226:227], v[212:213], v[228:229] op_sel:[1,1,0] op_sel_hi:[1,0,1] neg_lo:[0,1,0]
v_cvt_pk_bf16_f32 v180, v226, -v227
v_pk_mul_f32 v[228:229], v[226:227], v[212:213] op_sel_hi:[0,1]
v_pk_fma_f32 v[226:227], v[226:227], v[212:213], v[228:229] op_sel:[1,1,0] op_sel_hi:[1,0,1] neg_lo:[0,1,0]
v_cvt_pk_bf16_f32 v181, v226, -v227
v_pk_mul_f32 v[228:229], v[226:227], v[212:213] op_sel_hi:[0,1]
v_pk_fma_f32 v[226:227], v[226:227], v[212:213], v[228:229] op_sel:[1,1,0] op_sel_hi:[1,0,1] neg_lo:[0,1,0]
v_cvt_pk_bf16_f32 v182, v226, -v227
v_pk_mul_f32 v[228:229], v[226:227], v[212:213] op_sel_hi:[0,1]
v_pk_fma_f32 v[226:227], v[226:227], v[212:213], v[228:229] op_sel:[1,1,0] op_sel_hi:[1,0,1] neg_lo:[0,1,0]
v_cvt_pk_bf16_f32 v183, v226, -v227
ds_write_addtid_b32 v176 offset:8976
ds_write_addtid_b32 v177 offset:9248
ds_write_addtid_b32 v178 offset:9520
ds_write_addtid_b32 v179 offset:9792
ds_write_addtid_b32 v180 offset:10064
ds_write_addtid_b32 v181 offset:10336
ds_write_addtid_b32 v182 offset:10608
ds_write_addtid_b32 v183 offset:10880
v_pk_mul_f32 v[228:229], v[226:227], v[212:213] op_sel_hi:[0,1]
v_pk_fma_f32 v[226:227], v[226:227], v[212:213], v[228:229] op_sel:[1,1,0] op_sel_hi:[1,0,1] neg_lo:[0,1,0]
v_cvt_pk_bf16_f32 v176, v226, -v227
v_pk_mul_f32 v[228:229], v[226:227], v[212:213] op_sel_hi:[0,1]
v_pk_fma_f32 v[226:227], v[226:227], v[212:213], v[228:229] op_sel:[1,1,0] op_sel_hi:[1,0,1] neg_lo:[0,1,0]
v_cvt_pk_bf16_f32 v177, v226, -v227
v_pk_mul_f32 v[228:229], v[226:227], v[212:213] op_sel_hi:[0,1]
v_pk_fma_f32 v[226:227], v[226:227], v[212:213], v[228:229] op_sel:[1,1,0] op_sel_hi:[1,0,1] neg_lo:[0,1,0]
v_cvt_pk_bf16_f32 v178, v226, -v227
v_pk_mul_f32 v[228:229], v[226:227], v[212:213] op_sel_hi:[0,1]
v_pk_fma_f32 v[226:227], v[226:227], v[212:213], v[228:229] op_sel:[1,1,0] op_sel_hi:[1,0,1] neg_lo:[0,1,0]
v_cvt_pk_bf16_f32 v179, v226, -v227
v_pk_mul_f32 v[228:229], v[226:227], v[212:213] op_sel_hi:[0,1]
v_pk_fma_f32 v[226:227], v[226:227], v[212:213], v[228:229] op_sel:[1,1,0] op_sel_hi:[1,0,1] neg_lo:[0,1,0]
v_cvt_pk_bf16_f32 v180, v226, -v227
v_pk_mul_f32 v[228:229], v[226:227], v[212:213] op_sel_hi:[0,1]
v_pk_fma_f32 v[226:227], v[226:227], v[212:213], v[228:229] op_sel:[1,1,0] op_sel_hi:[1,0,1] neg_lo:[0,1,0]
v_cvt_pk_bf16_f32 v181, v226, -v227
v_pk_mul_f32 v[228:229], v[226:227], v[212:213] op_sel_hi:[0,1]
v_pk_fma_f32 v[226:227], v[226:227], v[212:213], v[228:229] op_sel:[1,1,0] op_sel_hi:[1,0,1] neg_lo:[0,1,0]
v_cvt_pk_bf16_f32 v182, v226, -v227
v_pk_mul_f32 v[228:229], v[226:227], v[212:213] op_sel_hi:[0,1]
v_pk_fma_f32 v[226:227], v[226:227], v[212:213], v[228:229] op_sel:[1,1,0] op_sel_hi:[1,0,1] neg_lo:[0,1,0]
v_cvt_pk_bf16_f32 v183, v226, -v227
ds_write_addtid_b32 v176 offset:11152
ds_write_addtid_b32 v177 offset:11424
ds_write_addtid_b32 v178 offset:11696
ds_write_addtid_b32 v179 offset:11968
ds_write_addtid_b32 v180 offset:12240
ds_write_addtid_b32 v181 offset:12512
ds_write_addtid_b32 v182 offset:12784
ds_write_addtid_b32 v183 offset:13056
v_pk_mul_f32 v[228:229], v[226:227], v[212:213] op_sel_hi:[0,1]
v_pk_fma_f32 v[226:227], v[226:227], v[212:213], v[228:229] op_sel:[1,1,0] op_sel_hi:[1,0,1] neg_lo:[0,1,0]
v_cvt_pk_bf16_f32 v176, v226, -v227
v_pk_mul_f32 v[228:229], v[226:227], v[212:213] op_sel_hi:[0,1]
v_pk_fma_f32 v[226:227], v[226:227], v[212:213], v[228:229] op_sel:[1,1,0] op_sel_hi:[1,0,1] neg_lo:[0,1,0]
v_cvt_pk_bf16_f32 v177, v226, -v227
v_pk_mul_f32 v[228:229], v[226:227], v[212:213] op_sel_hi:[0,1]
v_pk_fma_f32 v[226:227], v[226:227], v[212:213], v[228:229] op_sel:[1,1,0] op_sel_hi:[1,0,1] neg_lo:[0,1,0]
v_cvt_pk_bf16_f32 v178, v226, -v227
v_pk_mul_f32 v[228:229], v[226:227], v[212:213] op_sel_hi:[0,1]
v_pk_fma_f32 v[226:227], v[226:227], v[212:213], v[228:229] op_sel:[1,1,0] op_sel_hi:[1,0,1] neg_lo:[0,1,0]
v_cvt_pk_bf16_f32 v179, v226, -v227
ds_write_addtid_b32 v176 offset:13328
ds_write_addtid_b32 v177 offset:13600
ds_write_addtid_b32 v178 offset:13872
ds_write_addtid_b32 v179 offset:14144
ds_read_b128 v[96:99], v16 offset:0
ds_read_b128 v[100:103], v16 offset:5712
ds_read_b128 v[104:107], v16 offset:32
ds_read_b128 v[108:111], v16 offset:5744
ds_read_b128 v[112:115], v16 offset:64
ds_read_b128 v[116:119], v16 offset:5776
ds_read_b128 v[120:123], v16 offset:96
ds_read_b128 v[124:127], v16 offset:5808
ds_read_b128 v[128:131], v16 offset:128
ds_read_b128 v[132:135], v16 offset:5840
ds_read_b128 v[136:139], v16 offset:160
ds_read_b128 v[140:143], v16 offset:5872
ds_read_b128 v[144:147], v16 offset:192
ds_read_b128 v[148:151], v16 offset:5904
ds_read_b128 v[152:155], v16 offset:224
ds_read_b128 v[156:159], v16 offset:5936
v_mov_b64 v[202:203], v[222:223]
v_mov_b64 v[214:215], v[224:225]
s_add_u32 s6, s6, 1
s_cmp_lt_u32 s6, 3
s_cbranch_scc1 L3_kloop
s_waitcnt lgkmcnt(14)
v_mfma_f32_32x32x16_bf16 v[160:175], v[96:99], v[100:103], v[160:175]
s_waitcnt lgkmcnt(12)
v_mfma_f32_32x32x16_bf16 v[160:175], v[104:107], v[108:111], v[160:175]
s_waitcnt lgkmcnt(10)
v_mfma_f32_32x32x16_bf16 v[160:175], v[112:115], v[116:119], v[160:175]
s_waitcnt lgkmcnt(8)
v_mfma_f32_32x32x16_bf16 v[160:175], v[120:123], v[124:127], v[160:175]
s_waitcnt lgkmcnt(6)
v_mfma_f32_32x32x16_bf16 v[160:175], v[128:131], v[132:135], v[160:175]
s_waitcnt lgkmcnt(4)
v_mfma_f32_32x32x16_bf16 v[160:175], v[136:139], v[140:143], v[160:175]
s_waitcnt lgkmcnt(2)
v_mfma_f32_32x32x16_bf16 v[160:175], v[144:147], v[148:151], v[160:175]
s_waitcnt lgkmcnt(0)
v_mfma_f32_32x32x16_bf16 v[160:175], v[152:155], v[156:159], v[160:175]
s_nop 11
v_cvt_pk_bf16_f32 v176, v160, v161
v_cvt_pk_bf16_f32 v177, v162, v163
v_cvt_pk_bf16_f32 v178, v164, v165
v_cvt_pk_bf16_f32 v179, v166, v167
v_cvt_pk_bf16_f32 v180, v168, v169
v_cvt_pk_bf16_f32 v181, v170, v171
ds_write_b64 v17, v[176:177]
ds_write_b32 v18, v178
ds_write_b32 v19, v179
ds_write_b16 v20, v180 offset:1024
ds_write_b16_d16_hi v20, v180 offset:1088
ds_write_b16 v20, v181 offset:1152
ds_write_b16_d16_hi v20, v181 offset:1216
s_branch L2_join1
L4_k0:
ds_write_addtid_b32 v176 offset:272
ds_write_addtid_b32 v177 offset:544
ds_write_addtid_b32 v178 offset:816
ds_write_addtid_b32 v179 offset:1088
ds_write_addtid_b32 v180 offset:1360
ds_write_addtid_b32 v181 offset:1632
ds_write_addtid_b32 v182 offset:1904
ds_write_addtid_b32 v183 offset:2176
s_waitcnt vmcnt(0) lgkmcnt(0)
v_perm_b32 v196, v189, v188, v201
v_perm_b32 v197, v191, v190, v201
v_perm_b32 v198, v193, v192, v201
v_perm_b32 v199, v195, v194, v201
v_add_u32 v201, 0x02020000, v201
v_perm_b32 v232, v185, v184, v201
v_perm_b32 v233, v187, v186, v201
v_mul_f32 v232, v232, v242
v_mul_f32 v233, v233, v243
v_exp_f32 v234, v232
v_rndne_f32 v235, v233
v_mul_f32 v238, 0x43800000, v232
v_sub_f32 v235, v233, v235
v_mul_f32 v239, 0x43800000, v233
v_cos_f32 v236, v235
v_fract_f32 v239, v239
v_sin_f32 v237, v235
v_exp_f32 v238, v238
v_cos_f32 v240, v239
v_sin_f32 v241, v239
v_mul_f32 v222, v234, v236
v_mul_f32 v223, v234, v237
v_mul_f32 v224, v238, v240
v_mul_f32 v225, v238, v241
v_mov_b32 v6, 0
s_add_u32 s42, s42, 0x9e3779b9
v_add_u32 v3, s42, v15
v_and_b32 v3, 0xff, v3
v_mov_b32 v8, s42
s_lshl_b32 s65, s45, 7
v_add_u32 v14, s65, v14
v_lshlrev_b32 v10, 16, v10
v_lshlrev_b32 v11, 16, v11
v_lshlrev_b32 v62, 16, v62
s_lshl_b32 s65, s44, 8
v_add_u32 v39, s65, v39
s_branch L5_k1
L1_svc0:
v_and_b32 v4, 7, v5
v_lshrrev_b32 v5, 3, v5
s_and_b32 s65, s2, 3
s_lshl_b32 s65, s65, 6
s_lshr_b32 s66, s2, 5
s_add_u32 s65, s65, s66
s_and_b32 s66, s2, 4
s_lshl_b32 s66, s66, 8
s_add_u32 s65, s65, s66
s_and_b32 s66, s2, 24
s_lshl_b32 s66, s66, 5
s_add_u32 s65, s65, s66
s_mul_i32 s65, s65, 1280
v_mul_u32_u24 v6, 10240, v4
v_mul_u32_u24 v7, 20, v5
v_add3_u32 v6, v6, v7, s65
s_mul_i32 s65, s2, 10240
s_add_u32 s65, s65, 6295552
v_add_u32 v7, s65, v2
v_mov_b32 v240, -1
v_mov_b32 v241, -1
v_mov_b32 v242, -1
v_mov_b32 v243, -1
v_lshrrev_b32 v64, 4, v2
v_and_b32 v65, 0x30, v64
v_and_b32 v66, 15, v64
v_and_b32 v67, 1, v64
v_bfe_u32 v68, v64, 1, 3
v_and_b32 v69, 3, v64
v_bfe_u32 v70, v64, 2, 2
s_lshr_b32 s65, s3, 1
s_and_b32 s66, s3, 1
v_mov_b32 v76, 0
v_mov_b32 v77, 0
v_mov_b32 v78, 0
v_mov_b32 v79, 0
s_mul_i32 s67, s3, 4640
s_add_u32 s67, s67, 97824
v_add_u32 v71, s67, v2
ds_write_b128 v71, v[76:79]
s_mul_i32 s67, s65, 5152
s_lshl_b32 s68, s66, 10
s_add_u32 s67, s67, s68
s_add_u32 s67, s67, 116384
v_add_u32 v71, s67, v2
ds_write_b128 v71, v[76:79]
v_lshrrev_b32 v71, 3, v0
v_min_u32 v71, 11, v71
v_mul_u32_u24 v71, 4160, v71
v_and_b32 v72, 7, v64
v_mul_u32_u24 v15, 37, v72
v_min_u32 v72, 4, v72
v_lshl_add_u32 v71, v72, 4, v71
ds_write_b128 v71, v[76:79] offset:51984
v_min_u32 v71, 19, v64
v_lshlrev_b32 v14, 10, v71
v_lshrrev_b32 v71, 3, v64
v_and_b32 v72, 0x70, v2
v_mul_u32_u24 v16, 65792, v71
v_add_u32 v16, v72, v16
v_mul_u32_u24 v17, 400, v71
s_mov_b32 s67, 126688
v_add3_u32 v17, v17, v72, s67
v_lshrrev_b32 v71, 1, v65
v_add_u32 v71, v71, v70
v_mul_u32_u24 v71, 400, v71
v_add_u32 v71, s67, v71
v_lshl_add_u32 v18, v69, 4, v71
v_lshl_add_u32 v19, v67, 4, v71
v_and_b32 v72, 2, v64
v_lshl_add_u32 v19, v72, 2, v19
s_lshl_b32 s67, s3, 9
v_lshl_add_u32 v71, v64, 1, s67
s_mov_b32 s68, 4294933248
v_sub_u32 v72, 2047, v71
v_sub_u32 v73, 2046, v71
v_cvt_f32_i32 v24, v72
v_cvt_f32_i32 v25, v73
v_cvt_pk_bf16_f32 v25, v24, v25
v_and_b32 v24, 0xffff, v25
v_lshrrev_b32 v25, 16, v25
v_lshl_add_u32 v24, v24, 1, s68
v_lshl_add_u32 v25, v25, 1, s68
v_sub_u32 v72, 2045, v71
v_sub_u32 v73, 1919, v71
v_cvt_f32_i32 v26, v72
v_cvt_f32_i32 v27, v73
v_cvt_pk_bf16_f32 v27, v26, v27
v_and_b32 v26, 0xffff, v27
v_lshrrev_b32 v27, 16, v27
v_lshl_add_u32 v26, v26, 1, s68
v_lshl_add_u32 v27, v27, 1, s68
v_sub_u32 v72, 1918, v71
v_sub_u32 v73, 1917, v71
v_cvt_f32_i32 v28, v72
v_cvt_f32_i32 v29, v73
v_cvt_pk_bf16_f32 v29, v28, v29
v_and_b32 v28, 0xffff, v29
v_lshrrev_b32 v29, 16, v29
v_lshl_add_u32 v28, v28, 1, s68
v_lshl_add_u32 v29, v29, 1, s68
v_sub_u32 v72, 1791, v71
v_sub_u32 v73, 1790, v71
v_cvt_f32_i32 v30, v72
v_cvt_f32_i32 v31, v73
v_cvt_pk_bf16_f32 v31, v30, v31
v_and_b32 v30, 0xffff, v31
v_lshrrev_b32 v31, 16, v31
v_lshl_add_u32 v30, v30, 1, s68
v_lshl_add_u32 v31, v31, 1, s68
v_sub_u32 v72, 1789, v71
v_sub_u32 v73, 1663, v71
v_cvt_f32_i32 v32, v72
v_cvt_f32_i32 v33, v73
v_cvt_pk_bf16_f32 v33, v32, v33
v_and_b32 v32, 0xffff, v33
v_lshrrev_b32 v33, 16, v33
v_lshl_add_u32 v32, v32, 1, s68
v_lshl_add_u32 v33, v33, 1, s68
v_cmp_gt_i32 vcc, 128, v72
v_lshlrev_b32 v72, 1, v72
s_nop 0
v_cndmask_b32 v32, v32, v72, vcc
v_cmp_gt_i32 vcc, 128, v73
v_lshlrev_b32 v73, 1, v73
s_nop 0
v_cndmask_b32 v33, v33, v73, vcc
v_sub_u32 v72, 1662, v71
v_sub_u32 v73, 1661, v71
v_cvt_f32_i32 v34, v72
v_cvt_f32_i32 v35, v73
v_cvt_pk_bf16_f32 v35, v34, v35
v_and_b32 v34, 0xffff, v35
v_lshrrev_b32 v35, 16, v35
v_lshl_add_u32 v34, v34, 1, s68
v_lshl_add_u32 v35, v35, 1, s68
v_cmp_gt_i32 vcc, 128, v72
v_lshlrev_b32 v72, 1, v72
s_nop 0
v_cndmask_b32 v34, v34, v72, vcc
v_cmp_gt_i32 vcc, 128, v73
v_lshlrev_b32 v73, 1, v73
s_nop 0
v_cndmask_b32 v35, v35, v73, vcc
v_min_u32 v35, 1536, v35
v_sub_u32 v71, 3, v69
v_mul_u32_u24 v71, 4160, v71
v_lshlrev_b32 v72, 4, v70
v_sub_u32 v72, v65, v72
s_mul_i32 s67, s65, 16640
s_lshl_b32 s68, s66, 8
s_sub_u32 s67, s67, s68
s_add_u32 s67, s67, 48208
v_add3_u32 v36, v71, v72, s67
s_mul_i32 s67, s65, 9280
s_sub_u32 s67, s67, s68
s_add_u32 s67, s67, 98144
s_lshl_b32 s68, s3, 8
s_sub_u32 s68, 82000, s68
v_add3_u32 v37, v71, v72, s68
v_xor_b32 v71, 1, v67
v_mul_u32_u24 v72, 4640, v71
v_lshl_add_u32 v73, v68, 6, v65
v_add3_u32 v38, v72, v73, s67
v_mul_u32_u24 v72, 5152, v71
v_and_b32 v71, 8, v64
v_lshl_add_u32 v73, v71, 5, v73
s_lshl_b32 s68, s3, 8
s_sub_u32 s68, 117216, s68
v_add3_u32 v39, v72, v73, s68
v_mul_u32_u24 v71, 576, v67
v_lshl_add_u32 v71, v68, 4, v71
v_lshl_add_u32 v71, v65, 3, v71
s_mul_i32 s67, s3, 6528
s_add_u32 s67, s67, 126688
v_add_u32 v40, s67, v71
s_mul_i32 s67, s3, 2176
s_add_u32 s67, s67, 152800
v_add_u32 v41, s67, v71
v_lshrrev_b32 v71, 5, v64
s_lshl_b32 s67, s3, 9
s_add_u32 s67, s67, 97824
v_mul_u32_u24 v72, 1536, v71
v_add3_u32 v42, v72, v2, s67
v_bfe_u32 v72, v64, 2, 3
v_mul_u32_u24 v73, 13056, v71
v_lshl_add_u32 v73, v72, 4, v73
v_lshl_add_u32 v73, v69, 7, v73
s_mul_i32 s67, s3, 1088
s_add_u32 s67, s67, 126688
v_add_u32 v43, s67, v73
s_mul_i32 s67, s3, 327680
v_mul_u32_u24 v73, 40960, v72
v_lshl_add_u32 v73, v71, 6, v73
v_lshlrev_b32 v71, 4, v69
v_add3_u32 v46, v73, v71, s67
v_mul_u32_u24 v73, 40960, v70
v_add3_u32 v47, v73, v71, s67
v_lshlrev_b32 v71, 4, v70
v_lshl_add_u32 v71, v69, 7, v71
s_mul_i32 s67, s65, 1088
s_lshl_b32 s68, s66, 6
s_add_u32 s67, s67, s68
s_add_u32 s68, s67, 131040
v_mul_u32_u24 v72, 408, v65
v_add3_u32 v44, v71, v72, s68
s_add_u32 s68, s67, 152800
v_mul_u32_u24 v72, 136, v65
v_add3_u32 v45, v71, v72, s68
s_waitcnt lgkmcnt(0)
s_and_b32 s45, s61, 7
s_and_b32 s65, s60, 0
s_lshl_b32 s65, s65, 3
s_add_u32 s45, s45, s65
s_lshr_b32 s72, s61, 3
s_lshr_b32 s46, s60, 0
s_lshl_b32 s46, s46, 2
s_add_u32 s46, s46, s72
s_mul_i32 s65, s43, 32896
s_add_u32 s65, s65, 1052672
s_add_u32 s48, s40, s65
s_addc_u32 s49, s41, 0
s_lshl_b32 s65, s47, 6
s_add_u32 s65, s65, 6291456
s_add_u32 s50, s40, s65
s_addc_u32 s51, s41, 0
s_lshl_b32 s65, s7, 6
s_mul_i32 s66, s44, 163840
s_add_u32 s65, s65, s66
s_add_u32 s65, s65, 6291456
s_add_u32 s52, s40, s65
s_addc_u32 s53, s41, 0
s_mul_i32 s65, s46, 40960
s_add_u32 s65, s65, 6291456
s_add_u32 s54, s40, s65
s_addc_u32 s55, s41, 0
s_add_u32 s58, s40, 4096
s_addc_u32 s59, s41, 0
v_add_u32 v9, 8192, v2
v_lshrrev_b32 v60, 8, v2
s_mul_i32 s65, s45, 384
s_lshl_b32 s66, s3, 6
s_add_u32 s66, s66, s65
v_lshl_add_u32 v48, v60, 4, s66
s_lshl_b32 s66, s3, 5
s_add_u32 s66, s66, s65
v_and_b32 v52, 1, v60
v_lshl_add_u32 v52, v52, 4, s66
v_lshrrev_b32 v53, 1, v60
v_lshl_add_u32 v52, v53, 3, v52
s_mul_i32 s65, s45, 160
s_and_b32 s66, s3, 1
s_lshl_b32 s66, s66, 6
s_add_u32 s66, s66, s65
v_lshl_add_u32 v54, v60, 4, s66
v_lshl_add_u32 v58, v60, 3, s65
global_load_dwordx3 v[96:98], v6, s[8:9] offset:0
global_load_dwordx3 v[100:102], v6, s[8:9] offset:8
global_load_dwordx3 v[104:106], v6, s[8:9] offset:160
global_load_dwordx3 v[108:110], v6, s[8:9] offset:168
global_load_dwordx3 v[112:114], v6, s[8:9] offset:320
global_load_dwordx3 v[116:118], v6, s[8:9] offset:328
global_load_dwordx3 v[120:122], v6, s[8:9] offset:480
global_load_dwordx3 v[124:126], v6, s[8:9] offset:488
global_load_dwordx3 v[128:130], v6, s[8:9] offset:640
global_load_dwordx3 v[132:134], v6, s[8:9] offset:648
global_load_dwordx3 v[136:138], v6, s[8:9] offset:800
global_load_dwordx3 v[140:142], v6, s[8:9] offset:808
global_load_dwordx3 v[144:146], v6, s[8:9] offset:960
global_load_dwordx3 v[148:150], v6, s[8:9] offset:968
global_load_dwordx3 v[152:154], v6, s[8:9] offset:1120
global_load_dwordx3 v[156:158], v6, s[8:9] offset:1128
global_store_dwordx4 v7, v[240:243], s[40:41] offset:-4096 sc1
global_store_dwordx4 v7, v[240:243], s[40:41] offset:-3072 sc1
global_store_dwordx4 v7, v[240:243], s[40:41] offset:-2048 sc1
global_store_dwordx4 v7, v[240:243], s[40:41] offset:-1024 sc1
global_store_dwordx4 v7, v[240:243], s[40:41] offset:0 sc1
global_store_dwordx4 v7, v[240:243], s[40:41] offset:1024 sc1
global_store_dwordx4 v7, v[240:243], s[40:41] offset:2048 sc1
global_store_dwordx4 v7, v[240:243], s[40:41] offset:3072 sc1
v_add_u32 v7, 4096, v7
global_store_dwordx4 v7, v[240:243], s[40:41] offset:0 sc1
global_store_dwordx4 v7, v[240:243], s[40:41] offset:1024 sc1
s_load_dword s42, s[40:41], 0
s_cmp_ge_u32 s2, 160
s_cbranch_scc1 L8_rtj
s_mul_i32 s65, s61, 98304
s_mul_i32 s66, s60, 384
s_add_u32 s65, s65, s66
v_mul_u32_u24 v252, 3072, v5
v_lshl_add_u32 v252, v4, 4, v252
v_add_u32 v252, s65, v252
global_load_dwordx4 v[160:163], v252, s[28:29] offset:0
global_load_dwordx4 v[164:167], v252, s[28:29] offset:128
global_load_dwordx4 v[168:171], v252, s[28:29] offset:256
v_add_u32 v252, 24576, v252
global_load_dwordx4 v[180:183], v252, s[28:29] offset:0
global_load_dwordx4 v[184:187], v252, s[28:29] offset:128
global_load_dwordx4 v[188:191], v252, s[28:29] offset:256
v_add_u32 v252, 24576, v252
global_load_dwordx4 v[200:203], v252, s[28:29] offset:0
global_load_dwordx4 v[204:207], v252, s[28:29] offset:128
global_load_dwordx4 v[208:211], v252, s[28:29] offset:256
v_add_u32 v252, 24576, v252
global_load_dwordx4 v[220:223], v252, s[28:29] offset:0
global_load_dwordx4 v[224:227], v252, s[28:29] offset:128
global_load_dwordx4 v[228:231], v252, s[28:29] offset:256
L8_rtj:
s_add_u32 s80, s40, 1048576
s_addc_u32 s81, s41, 0
s_and_b32 s81, s81, 0xffff
s_mov_b32 s82, 4210688
s_mov_b32 s83, 0x20000
s_mov_b32 s84, 0
s_mov_b32 s85, 32896
s_mov_b32 s86, 526336
s_mov_b32 s87, 559232
s_mov_b32 s88, 1052672
s_mov_b32 s89, 1085568
s_mov_b32 s90, 1579008
s_mov_b32 s91, 1611904
s_mov_b32 s92, 2105344
s_mov_b32 s93, 2138240
s_mov_b32 s94, 2631680
s_mov_b32 s95, 2664576
s_mov_b32 s96, 3158016
s_mov_b32 s97, 3190912
s_mov_b32 s98, 3684352
s_mov_b32 s99, 3717248
v_mov_b32 v248, 0x3f803f80
s_cmp_ge_u32 s2, 160
s_cbranch_scc1 L9_lnb
s_waitcnt vmcnt(36)
v_mov_b32 v244, 0
v_mov_b32 v245, 0
v_mov_b32 v246, 0
v_mov_b32 v247, 0
v_dot2c_f32_bf16 v244, v96, v248
v_dot2c_f32_bf16 v246, v96, v96
v_dot2c_f32_bf16 v245, v97, v248
v_dot2c_f32_bf16 v247, v97, v97
v_dot2c_f32_bf16 v244, v98, v248
v_dot2c_f32_bf16 v246, v98, v98
v_dot2c_f32_bf16 v245, v101, v248
v_dot2c_f32_bf16 v247, v101, v101
v_dot2c_f32_bf16 v244, v102, v248
v_dot2c_f32_bf16 v246, v102, v102
s_waitcnt vmcnt(34)
v_dot2c_f32_bf16 v244, v104, v248
v_dot2c_f32_bf16 v246, v104, v104
v_dot2c_f32_bf16 v245, v105, v248
v_dot2c_f32_bf16 v247, v105, v105
v_dot2c_f32_bf16 v244, v106, v248
v_dot2c_f32_bf16 v246, v106, v106
v_dot2c_f32_bf16 v245, v109, v248
v_dot2c_f32_bf16 v247, v109, v109
v_dot2c_f32_bf16 v244, v110, v248
v_dot2c_f32_bf16 v246, v110, v110
s_waitcnt vmcnt(32)
v_dot2c_f32_bf16 v244, v112, v248
v_dot2c_f32_bf16 v246, v112, v112
v_dot2c_f32_bf16 v245, v113, v248
v_dot2c_f32_bf16 v247, v113, v113
v_dot2c_f32_bf16 v244, v114, v248
v_dot2c_f32_bf16 v246, v114, v114
v_dot2c_f32_bf16 v245, v117, v248
v_dot2c_f32_bf16 v247, v117, v117
v_dot2c_f32_bf16 v244, v118, v248
v_dot2c_f32_bf16 v246, v118, v118
s_waitcnt vmcnt(30)
v_dot2c_f32_bf16 v244, v120, v248
v_dot2c_f32_bf16 v246, v120, v120
v_dot2c_f32_bf16 v245, v121, v248
v_dot2c_f32_bf16 v247, v121, v121
v_dot2c_f32_bf16 v244, v122, v248
v_dot2c_f32_bf16 v246, v122, v122
v_dot2c_f32_bf16 v245, v125, v248
v_dot2c_f32_bf16 v247, v125, v125
v_dot2c_f32_bf16 v244, v126, v248
v_dot2c_f32_bf16 v246, v126, v126
s_waitcnt vmcnt(28)
v_dot2c_f32_bf16 v244, v128, v248
v_dot2c_f32_bf16 v246, v128, v128
v_dot2c_f32_bf16 v245, v129, v248
v_dot2c_f32_bf16 v247, v129, v129
v_dot2c_f32_bf16 v244, v130, v248
v_dot2c_f32_bf16 v246, v130, v130
v_dot2c_f32_bf16 v245, v133, v248
v_dot2c_f32_bf16 v247, v133, v133
v_dot2c_f32_bf16 v244, v134, v248
v_dot2c_f32_bf16 v246, v134, v134
s_waitcnt vmcnt(26)
v_dot2c_f32_bf16 v244, v136, v248
v_dot2c_f32_bf16 v246, v136, v136
v_dot2c_f32_bf16 v245, v137, v248
v_dot2c_f32_bf16 v247, v137, v137
v_dot2c_f32_bf16 v244, v138, v248
v_dot2c_f32_bf16 v246, v138, v138
v_dot2c_f32_bf16 v245, v141, v248
v_dot2c_f32_bf16 v247, v141, v141
v_dot2c_f32_bf16 v244, v142, v248
v_dot2c_f32_bf16 v246, v142, v142
s_waitcnt vmcnt(24)
v_dot2c_f32_bf16 v244, v144, v248
v_dot2c_f32_bf16 v246, v144, v144
v_dot2c_f32_bf16 v245, v145, v248
v_dot2c_f32_bf16 v247, v145, v145
v_dot2c_f32_bf16 v244, v146, v248
v_dot2c_f32_bf16 v246, v146, v146
v_dot2c_f32_bf16 v245, v149, v248
v_dot2c_f32_bf16 v247, v149, v149
v_dot2c_f32_bf16 v244, v150, v248
v_dot2c_f32_bf16 v246, v150, v150
s_waitcnt vmcnt(22)
v_dot2c_f32_bf16 v244, v152, v248
v_dot2c_f32_bf16 v246, v152, v152
v_dot2c_f32_bf16 v245, v153, v248
v_dot2c_f32_bf16 v247, v153, v153
v_dot2c_f32_bf16 v244, v154, v248
v_dot2c_f32_bf16 v246, v154, v154
v_dot2c_f32_bf16 v245, v157, v248
v_dot2c_f32_bf16 v247, v157, v157
v_dot2c_f32_bf16 v244, v158, v248
v_dot2c_f32_bf16 v246, v158, v158
s_waitcnt vmcnt(12)
s_branch L10_lnj
L9_lnb:
s_waitcnt vmcnt(24)
v_mov_b32 v244, 0
v_mov_b32 v245, 0
v_mov_b32 v246, 0
v_mov_b32 v247, 0
v_dot2c_f32_bf16 v244, v96, v248
v_dot2c_f32_bf16 v246, v96, v96
v_dot2c_f32_bf16 v245, v97, v248
v_dot2c_f32_bf16 v247, v97, v97
v_dot2c_f32_bf16 v244, v98, v248
v_dot2c_f32_bf16 v246, v98, v98
v_dot2c_f32_bf16 v245, v101, v248
v_dot2c_f32_bf16 v247, v101, v101
v_dot2c_f32_bf16 v244, v102, v248
v_dot2c_f32_bf16 v246, v102, v102
s_waitcnt vmcnt(22)
v_dot2c_f32_bf16 v244, v104, v248
v_dot2c_f32_bf16 v246, v104, v104
v_dot2c_f32_bf16 v245, v105, v248
v_dot2c_f32_bf16 v247, v105, v105
v_dot2c_f32_bf16 v244, v106, v248
v_dot2c_f32_bf16 v246, v106, v106
v_dot2c_f32_bf16 v245, v109, v248
v_dot2c_f32_bf16 v247, v109, v109
v_dot2c_f32_bf16 v244, v110, v248
v_dot2c_f32_bf16 v246, v110, v110
s_waitcnt vmcnt(20)
v_dot2c_f32_bf16 v244, v112, v248
v_dot2c_f32_bf16 v246, v112, v112
v_dot2c_f32_bf16 v245, v113, v248
v_dot2c_f32_bf16 v247, v113, v113
v_dot2c_f32_bf16 v244, v114, v248
v_dot2c_f32_bf16 v246, v114, v114
v_dot2c_f32_bf16 v245, v117, v248
v_dot2c_f32_bf16 v247, v117, v117
v_dot2c_f32_bf16 v244, v118, v248
v_dot2c_f32_bf16 v246, v118, v118
s_waitcnt vmcnt(18)
v_dot2c_f32_bf16 v244, v120, v248
v_dot2c_f32_bf16 v246, v120, v120
v_dot2c_f32_bf16 v245, v121, v248
v_dot2c_f32_bf16 v247, v121, v121
v_dot2c_f32_bf16 v244, v122, v248
v_dot2c_f32_bf16 v246, v122, v122
v_dot2c_f32_bf16 v245, v125, v248
v_dot2c_f32_bf16 v247, v125, v125
v_dot2c_f32_bf16 v244, v126, v248
v_dot2c_f32_bf16 v246, v126, v126
s_waitcnt vmcnt(16)
v_dot2c_f32_bf16 v244, v128, v248
v_dot2c_f32_bf16 v246, v128, v128
v_dot2c_f32_bf16 v245, v129, v248
v_dot2c_f32_bf16 v247, v129, v129
v_dot2c_f32_bf16 v244, v130, v248
v_dot2c_f32_bf16 v246, v130, v130
v_dot2c_f32_bf16 v245, v133, v248
v_dot2c_f32_bf16 v247, v133, v133
v_dot2c_f32_bf16 v244, v134, v248
v_dot2c_f32_bf16 v246, v134, v134
s_waitcnt vmcnt(14)
v_dot2c_f32_bf16 v244, v136, v248
v_dot2c_f32_bf16 v246, v136, v136
v_dot2c_f32_bf16 v245, v137, v248
v_dot2c_f32_bf16 v247, v137, v137
v_dot2c_f32_bf16 v244, v138, v248
v_dot2c_f32_bf16 v246, v138, v138
v_dot2c_f32_bf16 v245, v141, v248
v_dot2c_f32_bf16 v247, v141, v141
v_dot2c_f32_bf16 v244, v142, v248
v_dot2c_f32_bf16 v246, v142, v142
s_waitcnt vmcnt(12)
v_dot2c_f32_bf16 v244, v144, v248
v_dot2c_f32_bf16 v246, v144, v144
v_dot2c_f32_bf16 v245, v145, v248
v_dot2c_f32_bf16 v247, v145, v145
v_dot2c_f32_bf16 v244, v146, v248
v_dot2c_f32_bf16 v246, v146, v146
v_dot2c_f32_bf16 v245, v149, v248
v_dot2c_f32_bf16 v247, v149, v149
v_dot2c_f32_bf16 v244, v150, v248
v_dot2c_f32_bf16 v246, v150, v150
s_waitcnt vmcnt(10)
v_dot2c_f32_bf16 v244, v152, v248
v_dot2c_f32_bf16 v246, v152, v152
v_dot2c_f32_bf16 v245, v153, v248
v_dot2c_f32_bf16 v247, v153, v153
v_dot2c_f32_bf16 v244, v154, v248
v_dot2c_f32_bf16 v246, v154, v154
v_dot2c_f32_bf16 v245, v157, v248
v_dot2c_f32_bf16 v247, v157, v157
v_dot2c_f32_bf16 v244, v158, v248
v_dot2c_f32_bf16 v246, v158, v158
s_waitcnt vmcnt(0)
L10_lnj:
s_waitcnt lgkmcnt(0)
s_add_u32 s62, s42, 0x9e3779b9
v_add_f32 v244, v244, v245
v_add_f32 v245, v246, v247
v_add_u32 v3, s62, v15
v_and_b32 v3, 0xff, v3
v_add_f32_dpp v244, v244, v244 row_ror:8 row_mask:0xf bank_mask:0xf
v_add_f32_dpp v245, v245, v245 row_ror:8 row_mask:0xf bank_mask:0xf
v_mov_b32 v246, v244
v_mov_b32 v247, v245
s_lshl_b32 s65, s2, 7
v_permlane16_swap_b32 v246, v244
v_permlane16_swap_b32 v247, v245
v_add_f32 v244, v244, v246
v_add_f32 v245, v245, v247
v_mov_b32 v246, v244
v_mov_b32 v247, v245
v_add_u32 v16, s65, v16
v_permlane32_swap_b32 v246, v244
v_permlane32_swap_b32 v247, v245
v_add_f32 v244, v244, v246
v_add_f32 v245, v245, v247
v_mul_f32 v244, 0x3acccccd, v244
v_mul_f32 v245, 0x3acccccd, v245
v_fma_f32 v245, -v244, v244, v245
v_max_f32 v245, 0, v245
v_cvt_pk_bf16_f32 v249, v244, v244
v_cvt_pk_bf16_f32 v245, v245, v245
v_lshlrev_b32 v245, 16, v245
v_add_f32 v245, 0x3727c5ac, v245
v_cvt_pk_bf16_f32 v245, v245, v245
v_lshlrev_b32 v245, 16, v245
v_sqrt_f32 v245, v245
s_nop 0
v_cvt_pk_bf16_f32 v245, v245, v245
v_lshlrev_b32 v245, 16, v245
v_rcp_f32 v250, v245
v_xor_b32 v249, 0x80008000, v249
s_mov_b32 s65, 0xffffff00
s_mov_b32 s66, 0xffff
v_and_or_b32 v250, v250, s65, v3
v_bfi_b32 v98, s66, v98, v249
v_mov_b32 v99, v250
buffer_store_dwordx4 v[96:99], v16, s[80:83], s84 offen sc1
v_bfi_b32 v100, s66, v249, v100
v_mov_b32 v103, v250
buffer_store_dwordx4 v[100:103], v16, s[80:83], s85 offen sc1
v_bfi_b32 v106, s66, v106, v249
v_mov_b32 v107, v250
buffer_store_dwordx4 v[104:107], v16, s[80:83], s86 offen sc1
v_bfi_b32 v108, s66, v249, v108
v_mov_b32 v111, v250
buffer_store_dwordx4 v[108:111], v16, s[80:83], s87 offen sc1
v_bfi_b32 v114, s66, v114, v249
v_mov_b32 v115, v250
buffer_store_dwordx4 v[112:115], v16, s[80:83], s88 offen sc1
v_bfi_b32 v116, s66, v249, v116
v_mov_b32 v119, v250
buffer_store_dwordx4 v[116:119], v16, s[80:83], s89 offen sc1
v_bfi_b32 v122, s66, v122, v249
v_mov_b32 v123, v250
buffer_store_dwordx4 v[120:123], v16, s[80:83], s90 offen sc1
v_bfi_b32 v124, s66, v249, v124
v_mov_b32 v127, v250
buffer_store_dwordx4 v[124:127], v16, s[80:83], s91 offen sc1
v_bfi_b32 v130, s66, v130, v249
v_mov_b32 v131, v250
buffer_store_dwordx4 v[128:131], v16, s[80:83], s92 offen sc1
v_bfi_b32 v132, s66, v249, v132
v_mov_b32 v135, v250
buffer_store_dwordx4 v[132:135], v16, s[80:83], s93 offen sc1
v_bfi_b32 v138, s66, v138, v249
v_mov_b32 v139, v250
buffer_store_dwordx4 v[136:139], v16, s[80:83], s94 offen sc1
v_bfi_b32 v140, s66, v249, v140
v_mov_b32 v143, v250
buffer_store_dwordx4 v[140:143], v16, s[80:83], s95 offen sc1
v_bfi_b32 v146, s66, v146, v249
v_mov_b32 v147, v250
buffer_store_dwordx4 v[144:147], v16, s[80:83], s96 offen sc1
v_bfi_b32 v148, s66, v249, v148
v_mov_b32 v151, v250
buffer_store_dwordx4 v[148:151], v16, s[80:83], s97 offen sc1
v_bfi_b32 v154, s66, v154, v249
v_mov_b32 v155, v250
buffer_store_dwordx4 v[152:155], v16, s[80:83], s98 offen sc1
v_bfi_b32 v156, s66, v249, v156
v_mov_b32 v159, v250
buffer_store_dwordx4 v[156:159], v16, s[80:83], s99 offen sc1
global_load_ushort v10, v11, s[24:25]
global_load_ushort v11, v11, s[24:25] offset:2
global_load_ushort v62, v62, s[24:25]
s_cmp_ge_u32 s2, 160
s_cbranch_scc1 L12_rtd
s_mul_i32 s65, s60, 245760
s_mul_i32 s66, s61, 3072
s_add_u32 s65, s65, s66
s_add_u32 s65, s65, 9437184
v_add_u32 v251, s65, v2
s_waitcnt vmcnt(19)
ds_write_b128 v17, v[160:163] offset:0
ds_write_b128 v17, v[164:167] offset:128
ds_write_b128 v17, v[168:171] offset:256
ds_write_b128 v17, v[180:183] offset:3200
ds_write_b128 v17, v[184:187] offset:3328
ds_write_b128 v17, v[188:191] offset:3456
ds_write_b128 v17, v[200:203] offset:6400
ds_write_b128 v17, v[204:207] offset:6528
ds_write_b128 v17, v[208:211] offset:6656
ds_write_b128 v17, v[220:223] offset:9600
ds_write_b128 v17, v[224:227] offset:9728
ds_write_b128 v17, v[228:231] offset:9856
ds_read_b64_tr_b16 v[160:161], v18 offset:0
ds_read_b64_tr_b16 v[162:163], v18 offset:1600
ds_read_b64_tr_b16 v[164:165], v18 offset:8
ds_read_b64_tr_b16 v[166:167], v18 offset:1608
ds_read_b64_tr_b16 v[168:169], v19 offset:256
ds_read_b64_tr_b16 v[170:171], v19 offset:1856
ds_read_b64_tr_b16 v[172:173], v18 offset:64
ds_read_b64_tr_b16 v[174:175], v18 offset:1664
ds_read_b64_tr_b16 v[176:177], v18 offset:72
ds_read_b64_tr_b16 v[178:179], v18 offset:1672
ds_read_b64_tr_b16 v[180:181], v19 offset:288
ds_read_b64_tr_b16 v[182:183], v19 offset:1888
ds_read_b64_tr_b16 v[184:185], v18 offset:128
ds_read_b64_tr_b16 v[186:187], v18 offset:1728
ds_read_b64_tr_b16 v[188:189], v18 offset:136
ds_read_b64_tr_b16 v[190:191], v18 offset:1736
ds_read_b64_tr_b16 v[192:193], v19 offset:320
ds_read_b64_tr_b16 v[194:195], v19 offset:1920
ds_read_b64_tr_b16 v[196:197], v18 offset:192
ds_read_b64_tr_b16 v[198:199], v18 offset:1792
ds_read_b64_tr_b16 v[200:201], v18 offset:200
ds_read_b64_tr_b16 v[202:203], v18 offset:1800
ds_read_b64_tr_b16 v[204:205], v19 offset:352
ds_read_b64_tr_b16 v[206:207], v19 offset:1952
s_waitcnt lgkmcnt(14)
global_store_dwordx4 v251, v[160:163], s[40:41] offset:0 sc1
global_store_dwordx4 v251, v[164:167], s[40:41] offset:1024 sc1
global_store_dwordx4 v251, v[168:171], s[40:41] offset:2048 sc1
v_add_u32 v251, 61440, v251
s_waitcnt lgkmcnt(12)
global_store_dwordx4 v251, v[172:175], s[40:41] offset:0 sc1
global_store_dwordx4 v251, v[176:179], s[40:41] offset:1024 sc1
global_store_dwordx4 v251, v[180:183], s[40:41] offset:2048 sc1
v_add_u32 v251, 61440, v251
s_waitcnt lgkmcnt(6)
global_store_dwordx4 v251, v[184:187], s[40:41] offset:0 sc1
global_store_dwordx4 v251, v[188:191], s[40:41] offset:1024 sc1
global_store_dwordx4 v251, v[192:195], s[40:41] offset:2048 sc1
v_add_u32 v251, 61440, v251
s_waitcnt lgkmcnt(0)
global_store_dwordx4 v251, v[196:199], s[40:41] offset:0 sc1
global_store_dwordx4 v251, v[200:203], s[40:41] offset:1024 sc1
global_store_dwordx4 v251, v[204:207], s[40:41] offset:2048 sc1
s_waitcnt vmcnt(12)
s_branch L11_rt2b
L12_rtd:
s_sub_u32 s65, s2, 160
s_mul_i32 s65, s65, 20480
v_lshl_add_u32 v252, v2, 3, s65
global_load_dword v244, v252, s[32:33]
v_add_u32 v252, 8192, v252
global_load_dword v245, v252, s[32:33]
v_add_u32 v252, 4096, v252
global_load_dword v246, v252, s[32:33]
s_waitcnt vmcnt(3)
L11_rt2b:
s_lshl_b32 s65, s45, 2
s_add_u32 s65, s65, s3
s_mul_i32 s65, s65, 61440
s_add_u32 s65, s65, 9441280
s_add_u32 s84, s40, s65
s_addc_u32 s85, s41, 0
s_add_u32 s86, s84, 15360
s_addc_u32 s87, s85, 0
s_add_u32 s88, s84, 30720
s_addc_u32 s89, s85, 0
s_add_u32 s90, s84, 46080
s_addc_u32 s91, s85, 0
s_lshl_b32 s65, s44, 4
s_lshl_b32 s82, 0xffff, s65
s_mov_b32 s83, 0
s_mov_b32 s80, 0
s_mov_b32 s81, s82
s_mul_i32 s60, s3, 10240
s_min_u32 s65, s2, 191
s_mul_i32 s66, s65, 10240
s_add_u32 s32, s32, s66
s_addc_u32 s33, s33, 0
s_lshr_b32 s66, s65, 2
s_mul_i32 s66, s66, 5120
s_and_b32 s65, s65, 3
s_lshl_b32 s65, s65, 8
s_add_u32 s65, s65, s66
s_add_u32 s65, s65, 11534336
s_add_u32 s28, s40, s65
s_addc_u32 s29, s41, 0
s_cmp_lt_u32 s2, 192
s_cselect_b64 s[76:77], -1, 0
s_lshl_b32 s63, s3, 10
s_and_b32 s64, s63, 1024
s_lshl_b32 s65, s2, 7
s_lshl_b32 s66, s3, 2
s_add_u32 s65, s65, s66
s_add_u32 s65, s65, 131072
s_add_u32 s18, s40, s65
s_addc_u32 s19, s41, 0
s_and_b32 s7, s43, 1
s_lshl_b32 s7, s7, 1
s_add_u32 s7, s7, s44
s_mov_b32 s38, 0x3f80
s_mov_b32 s39, 0x3f800000
v_mov_b32 v6, 0
s_add_u32 s42, s42, 0x9e3779b9
v_add_u32 v3, s42, v15
v_and_b32 v3, 0xff, v3
v_mov_b32 v8, s42
s_lshl_b32 s65, s45, 7
v_add_u32 v14, s65, v14
v_lshlrev_b32 v10, 16, v10
v_lshlrev_b32 v11, 16, v11
v_lshlrev_b32 v62, 16, v62
s_lshl_b32 s65, s44, 8
v_add_u32 v39, s65, v39
L2_join1:
s_waitcnt lgkmcnt(0)
s_barrier
s_cmp_lg_u32 s3, 3
s_cbranch_scc1 L13_nf
s_lshl_b32 s65, s2, 7
v_mov_b32 v4, s65
s_cmp_ge_u32 s2, 160
s_cbranch_scc1 L13_nf
s_waitcnt vmcnt(0)
global_store_dword v4, v8, s[58:59] sc1
L13_nf:
global_load_dwordx4 v[64:67], v1, s[48:49] offset:-4096 sc1
global_load_dwordx4 v[68:71], v1, s[48:49] offset:0 sc1
s_add_u32 s70, s48, 8192
s_addc_u32 s71, s49, 0
global_load_dwordx4 v[72:75], v1, s[70:71] offset:-4096 sc1
global_load_dwordx4 v[76:79], v1, s[70:71] offset:0 sc1
s_add_u32 s70, s48, 16384
s_addc_u32 s71, s49, 0
global_load_dwordx4 v[80:83], v1, s[70:71] offset:-4096 sc1
global_load_dwordx4 v[84:87], v1, s[70:71] offset:0 sc1
s_add_u32 s70, s48, 24576
s_addc_u32 s71, s49, 0
global_load_dwordx4 v[88:91], v1, s[70:71] offset:-4096 sc1
global_load_dwordx4 v[92:95], v1, s[70:71] offset:0 sc1
ds_read_u16 v148, v24 offset:14416
ds_read_u16 v149, v25 offset:14416
ds_read_u16 v150, v26 offset:14416
ds_read_u16 v151, v27 offset:14416
ds_read_u16 v152, v28 offset:14416
ds_read_u16 v153, v29 offset:14416
ds_read_u16 v154, v30 offset:14416
ds_read_u16 v155, v31 offset:14416
ds_read_u16 v156, v32 offset:14416
ds_read_u16 v157, v33 offset:14416
ds_read_u16 v158, v34 offset:14416
ds_read_u16 v159, v35 offset:14416
ds_read_u16 v160, v24 offset:30384
ds_read_u16 v161, v25 offset:30384
ds_read_u16 v162, v26 offset:30384
ds_read_u16 v163, v27 offset:30384
ds_read_u16 v164, v28 offset:30384
ds_read_u16 v165, v29 offset:30384
ds_read_u16 v166, v30 offset:30384
ds_read_u16 v167, v31 offset:30384
ds_read_u16 v168, v32 offset:30384
ds_read_u16 v169, v33 offset:30384
ds_read_u16 v170, v34 offset:30384
ds_read_u16 v171, v35 offset:30384
ds_read_u16 v172, v24 offset:46352
ds_read_u16 v173, v25 offset:46352
ds_read_u16 v174, v26 offset:46352
ds_read_u16 v175, v27 offset:46352
ds_read_u16 v176, v28 offset:46352
ds_read_u16 v177, v29 offset:46352
ds_read_u16 v178, v30 offset:46352
ds_read_u16 v179, v31 offset:46352
ds_read_u16 v180, v32 offset:46352
ds_read_u16 v181, v33 offset:46352
ds_read_u16 v182, v34 offset:46352
ds_read_u16 v183, v35 offset:46352
s_add_u32 m0, s63, 0
s_add_u32 s70, s32, m0
s_addc_u32 s71, s33, 0
global_load_lds_dwordx4 v2, s[70:71]
s_add_u32 m0, s63, 4096
s_add_u32 s70, s32, m0
s_addc_u32 s71, s33, 0
global_load_lds_dwordx4 v2, s[70:71]
s_add_u32 m0, s64, 8192
s_add_u32 s70, s32, m0
s_addc_u32 s71, s33, 0
global_load_lds_dwordx4 v2, s[70:71]
s_add_u32 s70, s4, 0
s_addc_u32 s71, s5, 0
global_load_dwordx4 v[16:19], v1, s[70:71]
s_add_u32 s70, s4, 4096
s_addc_u32 s71, s5, 0
global_load_dwordx4 v[20:23], v1, s[70:71]
s_add_u32 s70, s4, 8192
s_addc_u32 s71, s5, 0
global_load_dwordx4 v[24:27], v1, s[70:71]
s_add_u32 s70, s4, 12288
s_addc_u32 s71, s5, 0
global_load_dwordx4 v[28:31], v1, s[70:71]
s_add_u32 s70, s4, 16384
s_addc_u32 s71, s5, 0
global_load_dwordx4 v[32:35], v1, s[70:71]
s_add_u32 s70, s4, 20480
s_addc_u32 s71, s5, 0
global_load_dwordx4 v[192:195], v1, s[70:71]
s_add_u32 m0, s63, 47900
s_waitcnt lgkmcnt(14)
v_lshl_or_b32 v196, v149, 16, v148
v_lshl_or_b32 v197, v150, 16, v149
v_lshl_or_b32 v198, v152, 16, v151
v_lshl_or_b32 v199, v153, 16, v152
v_lshl_or_b32 v200, v155, 16, v154
v_lshl_or_b32 v201, v156, 16, v155
v_lshl_or_b32 v202, v158, 16, v157
v_lshl_or_b32 v203, v159, 16, v158
ds_write_addtid_b32 v196 offset:4
ds_write_addtid_b32 v197 offset:4164
ds_write_addtid_b32 v196 offset:8320
ds_write_addtid_b32 v197 offset:12480
ds_write_addtid_b32 v198 offset:260
ds_write_addtid_b32 v199 offset:4420
ds_write_addtid_b32 v198 offset:8576
ds_write_addtid_b32 v199 offset:12736
ds_write_addtid_b32 v200 offset:516
ds_write_addtid_b32 v201 offset:4676
ds_write_addtid_b32 v200 offset:8832
ds_write_addtid_b32 v201 offset:12992
ds_write_addtid_b32 v202 offset:772
ds_write_addtid_b32 v203 offset:4932
ds_write_addtid_b32 v202 offset:9088
ds_write_addtid_b32 v203 offset:13248
s_waitcnt lgkmcnt(14)
v_lshl_or_b32 v204, v161, 16, v160
v_lshl_or_b32 v205, v162, 16, v161
v_lshl_or_b32 v206, v164, 16, v163
v_lshl_or_b32 v207, v165, 16, v164
v_lshl_or_b32 v208, v167, 16, v166
v_lshl_or_b32 v209, v168, 16, v167
v_lshl_or_b32 v210, v170, 16, v169
v_lshl_or_b32 v211, v171, 16, v170
ds_write_addtid_b32 v204 offset:16644
ds_write_addtid_b32 v205 offset:20804
ds_write_addtid_b32 v204 offset:24960
ds_write_addtid_b32 v205 offset:29120
ds_write_addtid_b32 v206 offset:16900
ds_write_addtid_b32 v207 offset:21060
ds_write_addtid_b32 v206 offset:25216
ds_write_addtid_b32 v207 offset:29376
ds_write_addtid_b32 v208 offset:17156
ds_write_addtid_b32 v209 offset:21316
ds_write_addtid_b32 v208 offset:25472
ds_write_addtid_b32 v209 offset:29632
ds_write_addtid_b32 v210 offset:17412
ds_write_addtid_b32 v211 offset:21572
ds_write_addtid_b32 v210 offset:25728
ds_write_addtid_b32 v211 offset:29888
s_waitcnt lgkmcnt(14)
v_lshl_or_b32 v212, v173, 16, v172
v_lshl_or_b32 v213, v174, 16, v173
v_lshl_or_b32 v214, v176, 16, v175
v_lshl_or_b32 v215, v177, 16, v176
v_lshl_or_b32 v216, v179, 16, v178
v_lshl_or_b32 v217, v180, 16, v179
v_lshl_or_b32 v218, v182, 16, v181
v_lshl_or_b32 v219, v183, 16, v182
ds_write_addtid_b32 v212 offset:33284
ds_write_addtid_b32 v213 offset:37444
ds_write_addtid_b32 v212 offset:41600
ds_write_addtid_b32 v213 offset:45760
ds_write_addtid_b32 v214 offset:33540
ds_write_addtid_b32 v215 offset:37700
ds_write_addtid_b32 v214 offset:41856
ds_write_addtid_b32 v215 offset:46016
ds_write_addtid_b32 v216 offset:33796
ds_write_addtid_b32 v217 offset:37956
ds_write_addtid_b32 v216 offset:42112
ds_write_addtid_b32 v217 offset:46272
ds_write_addtid_b32 v218 offset:34052
ds_write_addtid_b32 v219 offset:38212
ds_write_addtid_b32 v218 offset:42368
ds_write_addtid_b32 v219 offset:46528
s_waitcnt vmcnt(9)
s_mov_b32 s6, 0
L14_xw:
v_xor_b32 v96, v67, v3
v_xor_b32 v97, v71, v3
v_xor_b32 v98, v75, v3
v_xor_b32 v99, v79, v3
v_xor_b32 v100, v83, v3
v_xor_b32 v101, v87, v3
v_xor_b32 v102, v91, v3
v_xor_b32 v103, v95, v3
v_or3_b32 v4, v96, v97, v98
v_or3_b32 v4, v4, v99, v100
v_or3_b32 v4, v4, v101, v102
v_or_b32 v4, v4, v103
v_and_b32 v4, 0xff, v4
v_cmp_ne_u32 vcc, 0, v4
s_cbranch_vccnz L16_xr
L15_xok:
s_cmp_eq_u32 s7, 1
s_cbranch_scc1 L19_up1
s_cmp_eq_u32 s7, 2
s_cbranch_scc1 L20_up2
s_cmp_eq_u32 s7, 3
s_cbranch_scc1 L21_up3
L18_up0:
v_and_b32 v104, 0xffff0000, v66
v_and_b32 v105, 0xffff0000, v70
v_and_b32 v106, 0xffff0000, v74
v_and_b32 v107, 0xffff0000, v78
v_and_b32 v108, 0xffff0000, v82
v_and_b32 v109, 0xffff0000, v86
v_and_b32 v110, 0xffff0000, v90
v_and_b32 v111, 0xffff0000, v94
v_dot2_f32_bf16 v244, v65, s38, v104
v_dot2_f32_bf16 v245, v69, s38, v105
v_dot2_f32_bf16 v246, v73, s38, v106
v_dot2_f32_bf16 v247, v77, s38, v107
v_dot2_f32_bf16 v248, v81, s38, v108
v_dot2_f32_bf16 v249, v85, s38, v109
v_dot2_f32_bf16 v250, v89, s38, v110
v_dot2_f32_bf16 v251, v93, s38, v111
v_dot2_f32_bf16 v228, v64, s38, v104
v_dot2_f32_bf16 v229, v68, s38, v105
v_dot2_f32_bf16 v230, v72, s38, v106
v_dot2_f32_bf16 v231, v76, s38, v107
v_dot2_f32_bf16 v232, v80, s38, v108
v_dot2_f32_bf16 v233, v84, s38, v109
v_dot2_f32_bf16 v234, v88, s38, v110
v_dot2_f32_bf16 v235, v92, s38, v111
v_dot2_f32_bf16 v236, v64, s39, v104
v_dot2_f32_bf16 v237, v68, s39, v105
v_dot2_f32_bf16 v238, v72, s39, v106
v_dot2_f32_bf16 v239, v76, s39, v107
v_dot2_f32_bf16 v240, v80, s39, v108
v_dot2_f32_bf16 v241, v84, s39, v109
v_dot2_f32_bf16 v242, v88, s39, v110
v_dot2_f32_bf16 v243, v92, s39, v111
s_branch L17_upd
L19_up1:
v_and_b32 v104, 0xffff0000, v66
v_and_b32 v105, 0xffff0000, v70
v_and_b32 v106, 0xffff0000, v74
v_and_b32 v107, 0xffff0000, v78
v_and_b32 v108, 0xffff0000, v82
v_and_b32 v109, 0xffff0000, v86
v_and_b32 v110, 0xffff0000, v90
v_and_b32 v111, 0xffff0000, v94
v_dot2_f32_bf16 v244, v65, s38, v104
v_dot2_f32_bf16 v245, v69, s38, v105
v_dot2_f32_bf16 v246, v73, s38, v106
v_dot2_f32_bf16 v247, v77, s38, v107
v_dot2_f32_bf16 v248, v81, s38, v108
v_dot2_f32_bf16 v249, v85, s38, v109
v_dot2_f32_bf16 v250, v89, s38, v110
v_dot2_f32_bf16 v251, v93, s38, v111
v_dot2_f32_bf16 v228, v65, s39, v104
v_dot2_f32_bf16 v229, v69, s39, v105
v_dot2_f32_bf16 v230, v73, s39, v106
v_dot2_f32_bf16 v231, v77, s39, v107
v_dot2_f32_bf16 v232, v81, s39, v108
v_dot2_f32_bf16 v233, v85, s39, v109
v_dot2_f32_bf16 v234, v89, s39, v110
v_dot2_f32_bf16 v235, v93, s39, v111
v_dot2_f32_bf16 v236, v66, s38, v104
v_dot2_f32_bf16 v237, v70, s38, v105
v_dot2_f32_bf16 v238, v74, s38, v106
v_dot2_f32_bf16 v239, v78, s38, v107
v_dot2_f32_bf16 v240, v82, s38, v108
v_dot2_f32_bf16 v241, v86, s38, v109
v_dot2_f32_bf16 v242, v90, s38, v110
v_dot2_f32_bf16 v243, v94, s38, v111
s_branch L17_upd
L20_up2:
v_lshlrev_b32 v104, 16, v64
v_lshlrev_b32 v105, 16, v68
v_lshlrev_b32 v106, 16, v72
v_lshlrev_b32 v107, 16, v76
v_lshlrev_b32 v108, 16, v80
v_lshlrev_b32 v109, 16, v84
v_lshlrev_b32 v110, 16, v88
v_lshlrev_b32 v111, 16, v92
v_dot2_f32_bf16 v244, v65, s39, v104
v_dot2_f32_bf16 v245, v69, s39, v105
v_dot2_f32_bf16 v246, v73, s39, v106
v_dot2_f32_bf16 v247, v77, s39, v107
v_dot2_f32_bf16 v248, v81, s39, v108
v_dot2_f32_bf16 v249, v85, s39, v109
v_dot2_f32_bf16 v250, v89, s39, v110
v_dot2_f32_bf16 v251, v93, s39, v111
v_dot2_f32_bf16 v228, v64, s39, v104
v_dot2_f32_bf16 v229, v68, s39, v105
v_dot2_f32_bf16 v230, v72, s39, v106
v_dot2_f32_bf16 v231, v76, s39, v107
v_dot2_f32_bf16 v232, v80, s39, v108
v_dot2_f32_bf16 v233, v84, s39, v109
v_dot2_f32_bf16 v234, v88, s39, v110
v_dot2_f32_bf16 v235, v92, s39, v111
v_dot2_f32_bf16 v236, v65, s38, v104
v_dot2_f32_bf16 v237, v69, s38, v105
v_dot2_f32_bf16 v238, v73, s38, v106
v_dot2_f32_bf16 v239, v77, s38, v107
v_dot2_f32_bf16 v240, v81, s38, v108
v_dot2_f32_bf16 v241, v85, s38, v109
v_dot2_f32_bf16 v242, v89, s38, v110
v_dot2_f32_bf16 v243, v93, s38, v111
s_branch L17_upd
L21_up3:
v_lshlrev_b32 v104, 16, v64
v_lshlrev_b32 v105, 16, v68
v_lshlrev_b32 v106, 16, v72
v_lshlrev_b32 v107, 16, v76
v_lshlrev_b32 v108, 16, v80
v_lshlrev_b32 v109, 16, v84
v_lshlrev_b32 v110, 16, v88
v_lshlrev_b32 v111, 16, v92
v_dot2_f32_bf16 v244, v65, s39, v104
v_dot2_f32_bf16 v245, v69, s39, v105
v_dot2_f32_bf16 v246, v73, s39, v106
v_dot2_f32_bf16 v247, v77, s39, v107
v_dot2_f32_bf16 v248, v81, s39, v108
v_dot2_f32_bf16 v249, v85, s39, v109
v_dot2_f32_bf16 v250, v89, s39, v110
v_dot2_f32_bf16 v251, v93, s39, v111
v_dot2_f32_bf16 v228, v66, s38, v104
v_dot2_f32_bf16 v229, v70, s38, v105
v_dot2_f32_bf16 v230, v74, s38, v106
v_dot2_f32_bf16 v231, v78, s38, v107
v_dot2_f32_bf16 v232, v82, s38, v108
v_dot2_f32_bf16 v233, v86, s38, v109
v_dot2_f32_bf16 v234, v90, s38, v110
v_dot2_f32_bf16 v235, v94, s38, v111
v_dot2_f32_bf16 v236, v66, s39, v104
v_dot2_f32_bf16 v237, v70, s39, v105
v_dot2_f32_bf16 v238, v74, s39, v106
v_dot2_f32_bf16 v239, v78, s39, v107
v_dot2_f32_bf16 v240, v82, s39, v108
v_dot2_f32_bf16 v241, v86, s39, v109
v_dot2_f32_bf16 v242, v90, s39, v110
v_dot2_f32_bf16 v243, v94, s39, v111
L17_upd:
v_pk_mul_f32 v[128:129], v[244:245], v[96:97]
v_pk_mul_f32 v[130:131], v[246:247], v[98:99]
v_pk_mul_f32 v[132:133], v[248:249], v[100:101]
v_pk_mul_f32 v[134:135], v[250:251], v[102:103]
v_pk_mul_f32 v[112:113], v[228:229], v[96:97]
v_pk_mul_f32 v[114:115], v[230:231], v[98:99]
v_pk_mul_f32 v[116:117], v[232:233], v[100:101]
v_pk_mul_f32 v[118:119], v[234:235], v[102:103]
v_pk_mul_f32 v[120:121], v[236:237], v[96:97]
v_pk_mul_f32 v[122:123], v[238:239], v[98:99]
v_pk_mul_f32 v[124:125], v[240:241], v[100:101]
v_pk_mul_f32 v[126:127], v[242:243], v[102:103]
v_cvt_pk_bf16_f32 v144, v128, v129
v_cvt_pk_bf16_f32 v145, v130, v131
v_cvt_pk_bf16_f32 v146, v132, v133
v_cvt_pk_bf16_f32 v147, v134, v135
v_cvt_pk_bf16_f32 v136, v112, v113
v_cvt_pk_bf16_f32 v137, v114, v115
v_cvt_pk_bf16_f32 v138, v116, v117
v_cvt_pk_bf16_f32 v139, v118, v119
v_cvt_pk_bf16_f32 v140, v120, v121
v_cvt_pk_bf16_f32 v141, v122, v123
v_cvt_pk_bf16_f32 v142, v124, v125
v_cvt_pk_bf16_f32 v143, v126, v127
v_pk_add_f32 v[228:229], v[228:229], v[104:105] neg_lo:[0,1] neg_hi:[0,1]
v_pk_add_f32 v[230:231], v[230:231], v[106:107] neg_lo:[0,1] neg_hi:[0,1]
v_pk_add_f32 v[232:233], v[232:233], v[108:109] neg_lo:[0,1] neg_hi:[0,1]
v_pk_add_f32 v[234:235], v[234:235], v[110:111] neg_lo:[0,1] neg_hi:[0,1]
v_pk_fma_f32 v[228:229], v[112:113], v[10:11], v[228:229] op_sel:[0,0,0] op_sel_hi:[1,0,1]
v_pk_fma_f32 v[230:231], v[114:115], v[10:11], v[230:231] op_sel:[0,0,0] op_sel_hi:[1,0,1]
v_pk_fma_f32 v[232:233], v[116:117], v[10:11], v[232:233] op_sel:[0,0,0] op_sel_hi:[1,0,1]
v_pk_fma_f32 v[234:235], v[118:119], v[10:11], v[234:235] op_sel:[0,0,0] op_sel_hi:[1,0,1]
v_pk_add_f32 v[236:237], v[236:237], v[104:105] neg_lo:[0,1] neg_hi:[0,1]
v_pk_add_f32 v[238:239], v[238:239], v[106:107] neg_lo:[0,1] neg_hi:[0,1]
v_pk_add_f32 v[240:241], v[240:241], v[108:109] neg_lo:[0,1] neg_hi:[0,1]
v_pk_add_f32 v[242:243], v[242:243], v[110:111] neg_lo:[0,1] neg_hi:[0,1]
v_pk_fma_f32 v[236:237], v[120:121], v[10:11], v[236:237] op_sel:[0,1,0] op_sel_hi:[1,1,1]
v_pk_fma_f32 v[238:239], v[122:123], v[10:11], v[238:239] op_sel:[0,1,0] op_sel_hi:[1,1,1]
v_pk_fma_f32 v[240:241], v[124:125], v[10:11], v[240:241] op_sel:[0,1,0] op_sel_hi:[1,1,1]
v_pk_fma_f32 v[242:243], v[126:127], v[10:11], v[242:243] op_sel:[0,1,0] op_sel_hi:[1,1,1]
v_pk_add_f32 v[244:245], v[244:245], v[104:105] neg_lo:[0,1] neg_hi:[0,1]
v_pk_add_f32 v[246:247], v[246:247], v[106:107] neg_lo:[0,1] neg_hi:[0,1]
v_pk_add_f32 v[248:249], v[248:249], v[108:109] neg_lo:[0,1] neg_hi:[0,1]
v_pk_add_f32 v[250:251], v[250:251], v[110:111] neg_lo:[0,1] neg_hi:[0,1]
v_pk_fma_f32 v[244:245], v[128:129], v[62:63], v[244:245] op_sel:[0,0,0] op_sel_hi:[1,0,1]
v_pk_fma_f32 v[246:247], v[130:131], v[62:63], v[246:247] op_sel:[0,0,0] op_sel_hi:[1,0,1]
v_pk_fma_f32 v[248:249], v[132:133], v[62:63], v[248:249] op_sel:[0,0,0] op_sel_hi:[1,0,1]
v_pk_fma_f32 v[250:251], v[134:135], v[62:63], v[250:251] op_sel:[0,0,0] op_sel_hi:[1,0,1]
v_permlane32_swap_b32 v228, v236
v_permlane32_swap_b32 v229, v237
v_permlane32_swap_b32 v230, v238
v_permlane32_swap_b32 v231, v239
v_permlane32_swap_b32 v232, v240
v_permlane32_swap_b32 v233, v241
v_permlane32_swap_b32 v234, v242
v_permlane32_swap_b32 v235, v243
global_load_dword v60, v14, s[58:59] sc1
ds_write_b128 v42, v[144:147] offset:19584
ds_write_b64 v42, v[144:145] offset:24744
ds_write_b64 v42, v[146:147] offset:24752
ds_write_b128 v42, v[136:139] offset:512
ds_write_b64 v42, v[136:137] offset:5160
ds_write_b64 v42, v[138:139] offset:5168
ds_write_b128 v42, v[140:143] offset:9792
ds_write_b64 v42, v[140:141] offset:14440
ds_write_b64 v42, v[142:143] offset:14448
s_waitcnt lgkmcnt(0)
s_barrier
ds_read_b128 a[32:35], v37 offset:3264
ds_read_b128 a[36:39], v39 offset:192
ds_read_b128 a[40:43], v39 offset:1216
ds_read_b128 a[44:47], v37 offset:2240
ds_read_b128 a[48:51], v37 offset:3200
ds_read_b128 a[52:55], v39 offset:128
ds_read_b128 a[56:59], v39 offset:1152
ds_read_b128 a[60:63], v37 offset:2176
ds_read_b128 a[64:67], v37 offset:3136
ds_read_b128 a[68:71], v39 offset:64
ds_read_b128 a[72:75], v39 offset:1088
ds_read_b128 a[76:79], v37 offset:2112
s_waitcnt lgkmcnt(5)
v_mfma_f32_16x16x32_bf16 v[80:83], a[32:35], a[36:39], 0
ds_read_b128 a[80:83], v37 offset:3072
v_mfma_f32_16x16x32_bf16 v[84:87], a[32:35], a[40:43], 0
ds_read_b128 a[84:87], v39 offset:0
ds_read_b128 a[88:91], v39 offset:1024
v_mfma_f32_16x16x32_bf16 v[84:87], a[44:47], a[36:39], v[84:87]
ds_read_b128 a[92:95], v37 offset:2048
v_mfma_f32_16x16x32_bf16 v[80:83], a[48:51], a[52:55], v[80:83]
ds_read_b128 a[96:99], v36 offset:3776
v_mfma_f32_16x16x32_bf16 v[84:87], a[48:51], a[56:59], v[84:87]
ds_read_b128 a[100:103], v38 offset:192
ds_read_b128 a[104:107], v38 offset:704
s_waitcnt lgkmcnt(5)
v_mfma_f32_16x16x32_bf16 v[84:87], a[60:63], a[52:55], v[84:87]
ds_read_b128 a[108:111], v38 offset:1216
ds_read_b128 a[112:115], v38 offset:1728
v_mfma_f32_16x16x32_bf16 v[80:83], a[64:67], a[68:71], v[80:83]
ds_read_b128 a[116:119], v36 offset:3264
v_mfma_f32_16x16x32_bf16 v[84:87], a[64:67], a[72:75], v[84:87]
ds_read_b128 a[120:123], v36 offset:2752
v_mfma_f32_16x16x32_bf16 v[84:87], a[76:79], a[68:71], v[84:87]
ds_read_b128 a[124:127], v36 offset:2240
v_mfma_f32_16x16x32_bf16 v[80:83], a[80:83], a[84:87], v[80:83]
ds_read_b128 a[128:131], v36 offset:3712
s_waitcnt lgkmcnt(5)
v_mfma_f32_16x16x32_bf16 v[84:87], a[80:83], a[88:91], v[84:87]
ds_read_b128 a[132:135], v38 offset:128
v_mfma_f32_16x16x32_bf16 v[84:87], a[92:95], a[84:87], v[84:87]
ds_read_b128 a[136:139], v38 offset:640
v_mfma_f32_16x16x32_bf16 v[64:67], a[96:99], a[100:103], 0
ds_read_b128 v[112:115], v38 offset:1152
v_mfma_f32_16x16x32_bf16 v[68:71], a[96:99], a[104:107], 0
ds_read_b128 v[116:119], v38 offset:1664
v_mfma_f32_16x16x32_bf16 v[72:75], a[96:99], a[108:111], 0
ds_read_b128 v[120:123], v36 offset:3200
s_waitcnt lgkmcnt(7)
v_mfma_f32_16x16x32_bf16 v[76:79], a[96:99], a[112:115], 0
ds_read_b128 v[124:127], v36 offset:2688
ds_write_b128 v40, v[80:83] offset:4352
v_mfma_f32_16x16x32_bf16 v[68:71], a[116:119], a[100:103], v[68:71]
ds_read_b128 v[128:131], v36 offset:2176
v_mfma_f32_16x16x32_bf16 v[72:75], a[116:119], a[104:107], v[72:75]
ds_read_b128 v[132:135], v36 offset:3648
v_mfma_f32_16x16x32_bf16 v[76:79], a[116:119], a[108:111], v[76:79]
ds_read_b128 v[136:139], v38 offset:64
ds_write_b128 v40, v[84:87] offset:5440
v_mfma_f32_16x16x32_bf16 v[72:75], a[120:123], a[100:103], v[72:75]
ds_read_b128 v[140:143], v38 offset:576
v_mfma_f32_16x16x32_bf16 v[76:79], a[120:123], a[104:107], v[76:79]
ds_read_b128 v[144:147], v38 offset:1088
s_waitcnt lgkmcnt(8)
v_mfma_f32_16x16x32_bf16 v[76:79], a[124:127], a[100:103], v[76:79]
ds_read_b128 v[148:151], v38 offset:1600
v_mfma_f32_16x16x32_bf16 v[64:67], a[128:131], a[132:135], v[64:67]
ds_read_b128 v[152:155], v36 offset:3136
v_mfma_f32_16x16x32_bf16 v[68:71], a[128:131], a[136:139], v[68:71]
v_mfma_f32_16x16x32_bf16 v[72:75], a[128:131], v[112:115], v[72:75]
ds_read_b128 v[156:159], v36 offset:2624
s_waitcnt vmcnt(0)
s_mov_b32 s6, 0
v_cmp_ne_u32 vcc, v60, v8
s_cbranch_vccnz L22_fw
L23_fok:
v_mfma_f32_16x16x32_bf16 v[76:79], a[128:131], v[116:119], v[76:79]
v_mfma_f32_16x16x32_bf16 v[68:71], v[120:123], a[132:135], v[68:71]
ds_read_b128 v[160:163], v36 offset:2112
global_load_dwordx4 a[0:3], v2, s[84:85] offset:-4096 sc1
v_mfma_f32_16x16x32_bf16 v[72:75], v[120:123], a[136:139], v[72:75]
ds_read_b128 v[164:167], v36 offset:3584
s_waitcnt lgkmcnt(7)
s_barrier
ds_read_b128 v[216:219], v44
ds_read_b128 v[220:223], v44 offset:576
v_mfma_f32_16x16x32_bf16 v[76:79], v[120:123], v[112:115], v[76:79]
ds_read_b128 v[168:171], v38 offset:0
s_waitcnt lgkmcnt(8)
v_mfma_f32_16x16x32_bf16 v[72:75], v[124:127], a[132:135], v[72:75]
ds_read_b128 v[172:175], v38 offset:512
v_mfma_f32_16x16x32_bf16 v[76:79], v[124:127], a[136:139], v[76:79]
ds_read_b128 v[176:179], v38 offset:1024
v_mfma_f32_16x16x32_bf16 v[76:79], v[128:131], a[132:135], v[76:79]
ds_read_b128 v[180:183], v38 offset:1536
global_load_dwordx4 a[4:7], v2, s[84:85] offset:-3072 sc1
v_mfma_f32_16x16x32_bf16 v[64:67], v[132:135], v[136:139], v[64:67]
ds_read_b128 v[184:187], v36 offset:3072
s_waitcnt lgkmcnt(5)
s_mov_b64 exec, s[82:83]
v_add_f32 v216, v216, v244
v_add_f32 v220, v220, v248
v_add_f32 v217, v217, v245
v_add_f32 v221, v221, v249
v_add_f32 v218, v218, v246
v_add_f32 v222, v222, v250
v_add_f32 v219, v219, v247
v_add_f32 v223, v223, v251
s_mov_b64 exec, -1
v_mfma_f32_16x16x32_bf16 v[68:71], v[132:135], v[140:143], v[68:71]
v_mfma_f32_16x16x32_bf16 v[72:75], v[132:135], v[144:147], v[72:75]
ds_read_b128 v[188:191], v36 offset:2560
global_load_dwordx4 a[8:11], v2, s[84:85] offset:-2048 sc1
s_waitcnt lgkmcnt(10)
v_mfma_f32_16x16x32_bf16 v[76:79], v[132:135], v[148:151], v[76:79]
v_permlane32_swap_b32 v216, v220
v_permlane32_swap_b32 v217, v221
v_permlane32_swap_b32 v218, v222
v_mfma_f32_16x16x32_bf16 v[68:71], v[152:155], v[136:139], v[68:71]
ds_read_b128 a[140:143], v36 offset:2048
v_permlane32_swap_b32 v219, v223
v_add_f32 v216, v216, v220
v_mfma_f32_16x16x32_bf16 v[72:75], v[152:155], v[140:143], v[72:75]
ds_read_b128 a[144:147], v39 offset:2240
global_load_dwordx4 a[12:15], v2, s[84:85] offset:-1024 sc1
v_add_f32 v218, v218, v222
v_mfma_f32_16x16x32_bf16 v[76:79], v[152:155], v[144:147], v[76:79]
ds_read_b128 a[148:151], v39 offset:3264
v_add_f32 v217, v217, v221
v_add_f32 v219, v219, v223
v_mfma_f32_16x16x32_bf16 v[72:75], v[156:159], v[136:139], v[72:75]
v_permlane16_swap_b32 v216, v218
v_permlane16_swap_b32 v217, v219
v_add_f32 v216, v216, v218
v_mfma_f32_16x16x32_bf16 v[76:79], v[156:159], v[140:143], v[76:79]
v_add_f32 v217, v217, v219
v_cvt_pk_bf16_f32 v224, v216, v217
s_waitcnt lgkmcnt(5)
v_mfma_f32_16x16x32_bf16 v[76:79], v[160:163], v[136:139], v[76:79]
ds_read_b128 a[152:155], v37 offset:1216
global_load_dwordx4 a[16:19], v2, s[84:85] offset:0 sc1
v_cvt_pk_bf16_f32 v225, v216, v217
v_mfma_f32_16x16x32_bf16 v[64:67], v[164:167], v[168:171], v[64:67]
s_nop 0
v_permlane16_swap_b32 v224, v225
v_mov_b32 v226, v224
v_mov_b32 v227, v225
v_mfma_f32_16x16x32_bf16 v[68:71], v[164:167], v[172:175], v[68:71]
ds_read_b128 a[156:159], v37 offset:192
v_permlane32_swap_b32 v224, v226
v_permlane32_swap_b32 v225, v227
v_mfma_f32_16x16x32_bf16 v[72:75], v[164:167], v[176:179], v[72:75]
ds_read_b128 a[160:163], v39 offset:2176
s_mov_b64 exec, 0xffff
global_store_dwordx4 v47, v[224:227], s[52:53] sc1
s_mov_b64 exec, -1
v_mfma_f32_16x16x32_bf16 v[76:79], v[164:167], v[180:183], v[76:79]
ds_read_b128 a[164:167], v39 offset:3200
global_load_dwordx4 a[20:23], v2, s[84:85] offset:1024 sc1
s_waitcnt lgkmcnt(6)
v_mfma_f32_16x16x32_bf16 v[68:71], v[184:187], v[168:171], v[68:71]
ds_write_b128 v40, v[64:67] offset:0
v_mfma_f32_16x16x32_bf16 v[72:75], v[184:187], v[172:175], v[72:75]
v_mfma_f32_16x16x32_bf16 v[76:79], v[184:187], v[176:179], v[76:79]
ds_read_b128 a[168:171], v37 offset:1152
v_mfma_f32_16x16x32_bf16 v[72:75], v[188:191], v[168:171], v[72:75]
global_load_dwordx4 a[24:27], v2, s[84:85] offset:2048 sc1
v_mfma_f32_16x16x32_bf16 v[76:79], v[188:191], v[172:175], v[76:79]
ds_read_b128 a[172:175], v37 offset:128
ds_write_b128 v40, v[68:71] offset:1088
v_mfma_f32_16x16x32_bf16 v[76:79], a[140:143], v[168:171], v[76:79]
ds_read_b128 a[176:179], v39 offset:2112
s_waitcnt lgkmcnt(8)
v_mfma_f32_16x16x32_bf16 v[104:107], a[32:35], a[144:147], 0
ds_read_b128 a[180:183], v39 offset:3136
v_mfma_f32_16x16x32_bf16 v[108:111], a[32:35], a[148:151], 0
global_load_dwordx4 a[28:31], v2, s[84:85] offset:3072 sc1
ds_write_b128 v40, v[72:75] offset:2176
v_mfma_f32_16x16x32_bf16 v[104:107], a[44:47], a[40:43], v[104:107]
ds_write_b128 v40, v[76:79] offset:3264
v_mfma_f32_16x16x32_bf16 v[108:111], a[44:47], a[144:147], v[108:111]
ds_read_b128 a[184:187], v37 offset:1088
v_mfma_f32_16x16x32_bf16 v[104:107], a[152:155], a[36:39], v[104:107]
v_mfma_f32_16x16x32_bf16 v[108:111], a[152:155], a[40:43], v[108:111]
ds_read_b128 a[188:191], v37 offset:64
global_load_dwordx4 a[32:35], v9, s[84:85] offset:-4096 sc1
s_waitcnt vmcnt(11)
s_waitcnt lgkmcnt(2)
s_barrier
ds_read_b128 v[196:199], v43
ds_read_b128 v[200:203], v43 offset:576
ds_read_b128 v[204:207], v43 offset:6528
ds_read_b128 v[208:211], v43 offset:7104
s_waitcnt lgkmcnt(12)
v_mfma_f32_16x16x32_bf16 v[108:111], a[156:159], a[36:39], v[108:111]
ds_read_b128 a[192:195], v39 offset:2048
v_mfma_f32_16x16x32_bf16 v[104:107], a[48:51], a[160:163], v[104:107]
ds_read_b128 a[196:199], v39 offset:3072
v_mfma_f32_16x16x32_bf16 v[108:111], a[48:51], a[164:167], v[108:111]
v_mfma_f32_16x16x32_bf16 v[104:107], a[60:63], a[56:59], v[104:107]
global_load_dwordx4 a[36:39], v9, s[84:85] offset:-3072 sc1
v_mfma_f32_16x16x32_bf16 v[108:111], a[60:63], a[160:163], v[108:111]
ds_read_b128 a[60:63], v37 offset:1024
v_mfma_f32_16x16x32_bf16 v[104:107], a[168:171], a[52:55], v[104:107]
v_mfma_f32_16x16x32_bf16 v[108:111], a[168:171], a[56:59], v[108:111]
ds_read_b128 a[56:59], v37 offset:0
s_waitcnt lgkmcnt(4)
v_add_f32 v196, v196, v204
v_add_f32 v197, v197, v205
v_add_f32 v198, v198, v206
v_add_f32 v199, v199, v207
v_add_f32 v200, v200, v208
s_waitcnt lgkmcnt(9)
v_mfma_f32_16x16x32_bf16 v[108:111], a[172:175], a[52:55], v[108:111]
ds_read_b128 a[200:203], v38 offset:2240
global_load_dwordx4 a[40:43], v9, s[84:85] offset:-2048 sc1
v_add_f32 v201, v201, v209
v_add_f32 v202, v202, v210
v_add_f32 v203, v203, v211
v_add_f32 v196, v196, v228
v_add_f32 v197, v197, v229
v_add_f32 v198, v198, v230
v_mfma_f32_16x16x32_bf16 v[104:107], a[64:67], a[176:179], v[104:107]
ds_read_b128 a[204:207], v38 offset:2752
v_add_f32 v199, v199, v231
v_add_f32 v200, v200, v232
v_add_f32 v201, v201, v233
v_add_f32 v202, v202, v234
v_add_f32 v203, v203, v235
v_cvt_pk_bf16_f32 v212, v196, v197
v_cvt_pk_bf16_f32 v213, v198, v199
v_mfma_f32_16x16x32_bf16 v[108:111], a[64:67], a[180:183], v[108:111]
ds_read_b128 a[64:67], v38 offset:3264
v_cvt_pk_bf16_f32 v214, v200, v201
v_cvt_pk_bf16_f32 v215, v202, v203
global_store_dwordx4 v46, v[212:215], s[50:51] sc1
v_mfma_f32_16x16x32_bf16 v[104:107], a[76:79], a[72:75], v[104:107]
ds_read_b128 a[208:211], v38 offset:3776
v_mfma_f32_16x16x32_bf16 v[108:111], a[76:79], a[176:179], v[108:111]
global_load_dwordx4 a[44:47], v9, s[84:85] offset:-1024 sc1
v_mfma_f32_16x16x32_bf16 v[104:107], a[184:187], a[68:71], v[104:107]
s_nop 0
ds_read_b64_tr_b16 v[196:197], v31 offset:0
v_mfma_f32_16x16x32_bf16 v[108:111], a[184:187], a[72:75], v[108:111]
ds_read_b64_tr_b16 v[198:199], v31 offset:5120
s_waitcnt lgkmcnt(7)
v_mfma_f32_16x16x32_bf16 v[108:111], a[188:191], a[68:71], v[108:111]
ds_read_b64_tr_b16 v[200:201], v32 offset:0
ds_read_b64_tr_b16 v[202:203], v32 offset:5120
v_mfma_f32_16x16x32_bf16 v[104:107], a[80:83], a[192:195], v[104:107]
global_load_dwordx4 a[48:51], v9, s[84:85] offset:0 sc1
ds_read_b64_tr_b16 v[204:205], v33 offset:0
v_mfma_f32_16x16x32_bf16 v[108:111], a[80:83], a[196:199], v[108:111]
ds_read_b64_tr_b16 v[206:207], v33 offset:5120
v_mfma_f32_16x16x32_bf16 v[104:107], a[92:95], a[88:91], v[104:107]
v_mfma_f32_16x16x32_bf16 v[108:111], a[92:95], a[192:195], v[108:111]
s_mul_i32 s65, s2, 24576
s_mul_i32 s66, s3, 6144
s_add_u32 s65, s65, s66
s_add_u32 s65, s65, 13635584
v_add_u32 v4, s65, v2
v_mov_b32 v64, -1
v_mov_b32 v65, -1
v_mov_b32 v66, -1
v_mov_b32 v67, -1
global_store_dwordx4 v4, v[64:67], s[40:41] offset:-4096 sc1
v_mfma_f32_16x16x32_bf16 v[104:107], a[60:63], a[84:87], v[104:107]
v_mfma_f32_16x16x32_bf16 v[108:111], a[60:63], a[88:91], v[108:111]
global_load_dwordx4 a[52:55], v9, s[84:85] offset:1024 sc1
s_waitcnt lgkmcnt(8)
v_mfma_f32_16x16x32_bf16 v[108:111], a[56:59], a[84:87], v[108:111]
v_mfma_f32_16x16x32_bf16 v[88:91], a[96:99], a[200:203], 0
v_mfma_f32_16x16x32_bf16 v[92:95], a[96:99], a[204:207], 0
ds_read_b128 a[72:75], v36 offset:1728
s_waitcnt lgkmcnt(8)
v_mfma_f32_16x16x32_bf16 v[96:99], a[96:99], a[64:67], 0
s_waitcnt lgkmcnt(7)
v_mfma_f32_16x16x32_bf16 v[100:103], a[96:99], a[208:211], 0
global_load_dwordx4 a[56:59], v9, s[84:85] offset:2048 sc1
v_mfma_f32_16x16x32_bf16 v[88:91], a[116:119], a[112:115], v[88:91]
ds_write_b128 v41, v[104:107] offset:0
v_mfma_f32_16x16x32_bf16 v[92:95], a[116:119], a[200:203], v[92:95]
ds_read_b128 a[76:79], v36 offset:1216
v_mfma_f32_16x16x32_bf16 v[96:99], a[116:119], a[204:207], v[96:99]
ds_write_b128 v41, v[108:111] offset:1088
v_mfma_f32_16x16x32_bf16 v[100:103], a[116:119], a[64:67], v[100:103]
s_waitcnt lgkmcnt(4)
v_mfma_f32_16x16x32_bf16 v[88:91], a[120:123], a[108:111], v[88:91]
ds_read_b128 a[80:83], v36 offset:704
global_store_dwordx4 v4, v[64:67], s[40:41] offset:-3072 sc1
v_mfma_f32_16x16x32_bf16 v[92:95], a[120:123], a[112:115], v[92:95]
global_load_dwordx4 a[60:63], v2, s[86:87] offset:-4096 sc1
v_mfma_f32_16x16x32_bf16 v[96:99], a[120:123], a[200:203], v[96:99]
ds_read_b128 a[84:87], v36 offset:192
s_mov_b64 exec, s[76:77]
global_store_dwordx4 v34, v[196:199], s[28:29] sc1
global_store_dwordx4 v35, v[200:203], s[28:29] sc1
global_store_dwordx4 v192, v[204:207], s[28:29] sc1
s_mov_b64 exec, -1
v_mfma_f32_16x16x32_bf16 v[100:103], a[120:123], a[204:207], v[100:103]
ds_read_b128 a[88:91], v38 offset:2176
v_mfma_f32_16x16x32_bf16 v[88:91], a[124:127], a[104:107], v[88:91]
ds_read_b128 a[92:95], v38 offset:2688
v_mfma_f32_16x16x32_bf16 v[92:95], a[124:127], a[108:111], v[92:95]
ds_read_b128 a[96:99], v38 offset:3200
global_load_dwordx4 a[64:67], v2, s[86:87] offset:-3072 sc1
v_mfma_f32_16x16x32_bf16 v[96:99], a[124:127], a[112:115], v[96:99]
ds_read_b128 a[116:119], v38 offset:3712
s_add_u32 s50, s50, 1310720
s_addc_u32 s51, s51, 0
v_mfma_f32_16x16x32_bf16 v[100:103], a[124:127], a[200:203], v[100:103]
s_waitcnt lgkmcnt(7)
v_mfma_f32_16x16x32_bf16 v[88:91], a[72:75], a[100:103], v[88:91]
s_add_u32 s52, s52, 1310720
s_addc_u32 s53, s53, 0
v_mfma_f32_16x16x32_bf16 v[92:95], a[72:75], a[104:107], v[92:95]
v_mfma_f32_16x16x32_bf16 v[96:99], a[72:75], a[108:111], v[96:99]
global_load_dwordx4 a[68:71], v2, s[86:87] offset:-2048 sc1
v_mfma_f32_16x16x32_bf16 v[100:103], a[72:75], a[112:115], v[100:103]
v_mfma_f32_16x16x32_bf16 v[92:95], a[76:79], a[100:103], v[92:95]
global_store_dwordx4 v4, v[64:67], s[40:41] offset:-2048 sc1
v_mfma_f32_16x16x32_bf16 v[96:99], a[76:79], a[104:107], v[96:99]
s_waitcnt lgkmcnt(6)
s_barrier
s_nop 0
v_mfma_f32_16x16x32_bf16 v[100:103], a[76:79], a[108:111], v[100:103]
s_waitcnt lgkmcnt(2)
v_mfma_f32_16x16x32_bf16 v[96:99], a[80:83], a[100:103], v[96:99]
global_load_dwordx4 a[72:75], v2, s[86:87] offset:-1024 sc1
ds_read_b128 v[216:219], v45
v_mfma_f32_16x16x32_bf16 v[100:103], a[80:83], a[104:107], v[100:103]
ds_read_b128 v[220:223], v45 offset:576
global_load_dwordx4 v[48:51], v48, s[30:31]
v_mfma_f32_16x16x32_bf16 v[100:103], a[84:87], a[100:103], v[100:103]
global_load_dwordx2 v[52:53], v52, s[30:31] offset:256
global_load_dwordx4 v[54:57], v54, s[34:35]
v_mfma_f32_16x16x32_bf16 v[88:91], a[128:131], a[88:91], v[88:91]
global_load_dwordx2 v[58:59], v58, s[34:35] offset:128
v_mfma_f32_16x16x32_bf16 v[92:95], a[128:131], a[92:95], v[92:95]
ds_read_b128 a[100:103], v36 offset:1664
s_waitcnt lgkmcnt(4)
v_mfma_f32_16x16x32_bf16 v[96:99], a[128:131], a[96:99], v[96:99]
global_load_dwordx4 a[76:79], v2, s[86:87] offset:0 sc1
s_waitcnt lgkmcnt(3)
v_mfma_f32_16x16x32_bf16 v[100:103], a[128:131], a[116:119], v[100:103]
v_mfma_f32_16x16x32_bf16 v[88:91], v[120:123], v[116:119], v[88:91]
v_mfma_f32_16x16x32_bf16 v[92:95], v[120:123], a[88:91], v[92:95]
ds_read_b128 a[104:107], v36 offset:1152
v_mfma_f32_16x16x32_bf16 v[96:99], v[120:123], a[92:95], v[96:99]
global_store_dwordx4 v4, v[64:67], s[40:41] offset:-1024 sc1
v_mfma_f32_16x16x32_bf16 v[100:103], v[120:123], a[96:99], v[100:103]
global_load_dwordx4 a[80:83], v2, s[86:87] offset:1024 sc1
s_waitcnt lgkmcnt(2)
v_mfma_f32_16x16x32_bf16 v[88:91], v[124:127], v[112:115], v[88:91]
ds_read_b128 a[96:99], v36 offset:640
s_mov_b64 exec, s[80:81]
v_add_f32 v216, v216, v244
v_add_f32 v220, v220, v248
v_add_f32 v217, v217, v245
v_add_f32 v221, v221, v249
v_add_f32 v218, v218, v246
v_add_f32 v222, v222, v250
v_add_f32 v219, v219, v247
v_add_f32 v223, v223, v251
s_mov_b64 exec, -1
v_mfma_f32_16x16x32_bf16 v[92:95], v[124:127], v[116:119], v[92:95]
v_mfma_f32_16x16x32_bf16 v[96:99], v[124:127], a[88:91], v[96:99]
ds_read_b128 a[108:111], v36 offset:128
v_permlane32_swap_b32 v216, v220
v_mfma_f32_16x16x32_bf16 v[100:103], v[124:127], a[92:95], v[100:103]
ds_read_b128 a[112:115], v38 offset:2112
v_permlane32_swap_b32 v217, v221
v_mfma_f32_16x16x32_bf16 v[88:91], v[128:131], a[136:139], v[88:91]
ds_read_b128 a[116:119], v38 offset:2624
global_load_dwordx4 a[84:87], v2, s[86:87] offset:2048 sc1
v_mfma_f32_16x16x32_bf16 v[92:95], v[128:131], v[112:115], v[92:95]
ds_read_b128 a[120:123], v38 offset:3136
v_permlane32_swap_b32 v218, v222
v_mfma_f32_16x16x32_bf16 v[96:99], v[128:131], v[116:119], v[96:99]
ds_read_b128 a[124:127], v38 offset:3648
v_permlane32_swap_b32 v219, v223
v_mfma_f32_16x16x32_bf16 v[100:103], v[128:131], a[88:91], v[100:103]
v_add_f32 v216, v216, v220
s_waitcnt lgkmcnt(6)
v_mfma_f32_16x16x32_bf16 v[88:91], a[100:103], a[132:135], v[88:91]
v_add_f32 v218, v218, v222
v_add_f32 v217, v217, v221
v_mfma_f32_16x16x32_bf16 v[92:95], a[100:103], a[136:139], v[92:95]
global_load_dwordx4 a[88:91], v2, s[86:87] offset:3072 sc1
v_add_f32 v219, v219, v223
v_mfma_f32_16x16x32_bf16 v[96:99], a[100:103], v[112:115], v[96:99]
global_store_dwordx4 v4, v[64:67], s[40:41] offset:0 sc1
v_mfma_f32_16x16x32_bf16 v[100:103], a[100:103], v[116:119], v[100:103]
v_permlane16_swap_b32 v216, v218
v_permlane16_swap_b32 v217, v219
v_mfma_f32_16x16x32_bf16 v[92:95], a[104:107], a[132:135], v[92:95]
v_add_f32 v216, v216, v218
v_add_f32 v217, v217, v219
v_mfma_f32_16x16x32_bf16 v[96:99], a[104:107], a[136:139], v[96:99]
v_cvt_pk_bf16_f32 v224, v216, v217
v_cvt_pk_bf16_f32 v225, v216, v217
v_mfma_f32_16x16x32_bf16 v[100:103], a[104:107], v[112:115], v[100:103]
global_load_dwordx4 a[92:95], v9, s[86:87] offset:-4096 sc1
s_waitcnt lgkmcnt(2)
v_mfma_f32_16x16x32_bf16 v[96:99], a[96:99], a[132:135], v[96:99]
v_permlane16_swap_b32 v224, v225
v_mov_b32 v226, v224
v_mfma_f32_16x16x32_bf16 v[100:103], a[96:99], a[136:139], v[100:103]
v_mov_b32 v227, v225
v_permlane32_swap_b32 v224, v226
v_mfma_f32_16x16x32_bf16 v[100:103], a[108:111], a[132:135], v[100:103]
v_permlane32_swap_b32 v225, v227
s_mov_b64 exec, 0xffff
global_store_dwordx4 v47, v[224:227], s[52:53] sc1
s_mov_b64 exec, -1
v_mfma_f32_16x16x32_bf16 v[88:91], v[132:135], a[112:115], v[88:91]
v_mfma_f32_16x16x32_bf16 v[92:95], v[132:135], a[116:119], v[92:95]
ds_read_b128 a[128:131], v36 offset:1600
s_waitcnt lgkmcnt(2)
v_mfma_f32_16x16x32_bf16 v[96:99], v[132:135], a[120:123], v[96:99]
global_load_dwordx4 a[96:99], v9, s[86:87] offset:-3072 sc1
s_waitcnt lgkmcnt(1)
v_mfma_f32_16x16x32_bf16 v[100:103], v[132:135], a[124:127], v[100:103]
v_mfma_f32_16x16x32_bf16 v[88:91], v[152:155], v[148:151], v[88:91]
global_store_dwordx4 v4, v[64:67], s[40:41] offset:1024 sc1
v_mfma_f32_16x16x32_bf16 v[92:95], v[152:155], a[112:115], v[92:95]
ds_read_b128 a[124:127], v36 offset:1088
v_mfma_f32_16x16x32_bf16 v[96:99], v[152:155], a[116:119], v[96:99]
global_load_dwordx4 a[100:103], v9, s[86:87] offset:-2048 sc1
v_mfma_f32_16x16x32_bf16 v[100:103], v[152:155], a[120:123], v[100:103]
v_mfma_f32_16x16x32_bf16 v[88:91], v[156:159], v[144:147], v[88:91]
ds_read_b128 a[120:123], v36 offset:576
v_mfma_f32_16x16x32_bf16 v[92:95], v[156:159], v[148:151], v[92:95]
v_mfma_f32_16x16x32_bf16 v[96:99], v[156:159], a[112:115], v[96:99]
ds_read_b128 a[132:135], v36 offset:64
v_mfma_f32_16x16x32_bf16 v[100:103], v[156:159], a[116:119], v[100:103]
ds_read_b128 a[136:139], v38 offset:2048
global_load_dwordx4 a[104:107], v9, s[86:87] offset:-1024 sc1
v_mfma_f32_16x16x32_bf16 v[88:91], v[160:163], v[140:143], v[88:91]
ds_read_b128 a[212:215], v38 offset:2560
v_mfma_f32_16x16x32_bf16 v[92:95], v[160:163], v[144:147], v[92:95]
ds_read_b128 a[216:219], v38 offset:3072
v_mfma_f32_16x16x32_bf16 v[96:99], v[160:163], v[148:151], v[96:99]
ds_read_b128 a[220:223], v38 offset:3584
v_mfma_f32_16x16x32_bf16 v[100:103], v[160:163], a[112:115], v[100:103]
s_waitcnt lgkmcnt(6)
v_mfma_f32_16x16x32_bf16 v[88:91], a[128:131], v[136:139], v[88:91]
global_load_dwordx4 a[108:111], v9, s[86:87] offset:0 sc1
v_mfma_f32_16x16x32_bf16 v[92:95], a[128:131], v[140:143], v[92:95]
v_mfma_f32_16x16x32_bf16 v[96:99], a[128:131], v[144:147], v[96:99]
v_mfma_f32_16x16x32_bf16 v[100:103], a[128:131], v[148:151], v[100:103]
v_mfma_f32_16x16x32_bf16 v[92:95], a[124:127], v[136:139], v[92:95]
v_mfma_f32_16x16x32_bf16 v[96:99], a[124:127], v[140:143], v[96:99]
global_load_dwordx4 a[112:115], v9, s[86:87] offset:1024 sc1
v_mfma_f32_16x16x32_bf16 v[100:103], a[124:127], v[144:147], v[100:103]
s_waitcnt lgkmcnt(2)
v_mfma_f32_16x16x32_bf16 v[96:99], a[120:123], v[136:139], v[96:99]
v_mfma_f32_16x16x32_bf16 v[100:103], a[120:123], v[140:143], v[100:103]
s_waitcnt vmcnt(22)
global_store_dword v6, v8, s[18:19] sc1
v_mfma_f32_16x16x32_bf16 v[100:103], a[132:135], v[136:139], v[100:103]
v_mfma_f32_16x16x32_bf16 v[88:91], v[164:167], a[136:139], v[88:91]
global_load_dwordx4 a[116:119], v9, s[86:87] offset:2048 sc1
v_mfma_f32_16x16x32_bf16 v[92:95], v[164:167], a[212:215], v[92:95]
ds_read_b128 a[132:135], v36 offset:1536
s_waitcnt lgkmcnt(2)
v_mfma_f32_16x16x32_bf16 v[96:99], v[164:167], a[216:219], v[96:99]
s_waitcnt lgkmcnt(1)
v_mfma_f32_16x16x32_bf16 v[100:103], v[164:167], a[220:223], v[100:103]
v_mfma_f32_16x16x32_bf16 v[88:91], v[184:187], v[180:183], v[88:91]
v_mfma_f32_16x16x32_bf16 v[92:95], v[184:187], a[136:139], v[92:95]
ds_read_b128 a[224:227], v36 offset:1024
global_load_dwordx4 a[120:123], v2, s[88:89] offset:-4096 sc1
v_mfma_f32_16x16x32_bf16 v[96:99], v[184:187], a[212:215], v[96:99]
v_mfma_f32_16x16x32_bf16 v[100:103], v[184:187], a[216:219], v[100:103]
v_mfma_f32_16x16x32_bf16 v[88:91], v[188:191], v[176:179], v[88:91]
ds_read_b128 a[228:231], v36 offset:512
v_mfma_f32_16x16x32_bf16 v[92:95], v[188:191], v[180:183], v[92:95]
v_mfma_f32_16x16x32_bf16 v[96:99], v[188:191], a[136:139], v[96:99]
ds_read_b128 a[232:235], v36 offset:0
global_load_dwordx4 a[124:127], v2, s[88:89] offset:-3072 sc1
v_mfma_f32_16x16x32_bf16 v[100:103], v[188:191], a[212:215], v[100:103]
v_mfma_f32_16x16x32_bf16 v[88:91], a[140:143], v[172:175], v[88:91]
v_mfma_f32_16x16x32_bf16 v[92:95], a[140:143], v[176:179], v[92:95]
v_mfma_f32_16x16x32_bf16 v[96:99], a[140:143], v[180:183], v[96:99]
v_mfma_f32_16x16x32_bf16 v[100:103], a[140:143], a[136:139], v[100:103]
global_load_dwordx4 a[128:131], v2, s[88:89] offset:-2048 sc1
s_waitcnt lgkmcnt(2)
v_mfma_f32_16x16x32_bf16 v[88:91], a[132:135], v[168:171], v[88:91]
v_mfma_f32_16x16x32_bf16 v[92:95], a[132:135], v[172:175], v[92:95]
v_mfma_f32_16x16x32_bf16 v[96:99], a[132:135], v[176:179], v[96:99]
v_mfma_f32_16x16x32_bf16 v[100:103], a[132:135], v[180:183], v[100:103]
s_nop 4
ds_write_b128 v40, v[88:91] offset:0
v_mfma_f32_16x16x32_bf16 v[92:95], a[224:227], v[168:171], v[92:95]
global_load_dwordx4 a[132:135], v2, s[88:89] offset:-1024 sc1
v_mfma_f32_16x16x32_bf16 v[96:99], a[224:227], v[172:175], v[96:99]
v_mfma_f32_16x16x32_bf16 v[100:103], a[224:227], v[176:179], v[100:103]
s_waitcnt lgkmcnt(2)
v_mfma_f32_16x16x32_bf16 v[96:99], a[228:231], v[168:171], v[96:99]
s_nop 2
ds_write_b128 v40, v[92:95] offset:1088
v_mfma_f32_16x16x32_bf16 v[100:103], a[228:231], v[172:175], v[100:103]
s_waitcnt lgkmcnt(2)
v_mfma_f32_16x16x32_bf16 v[100:103], a[232:235], v[168:171], v[100:103]
global_load_dwordx4 a[136:139], v2, s[88:89] offset:0 sc1
ds_write_b128 v40, v[96:99] offset:2176
s_nop 5
ds_write_b128 v40, v[100:103] offset:3264
s_waitcnt vmcnt(11)
s_waitcnt lgkmcnt(0)
s_barrier
ds_read_b128 v[196:199], v43
ds_read_b128 v[200:203], v43 offset:576
ds_read_b128 v[204:207], v43 offset:6528
ds_read_b128 v[208:211], v43 offset:7104
v_mov_b32 v120, 0x3f803f80
v_mov_b32 v121, 0x3f803f80
v_mov_b32 v122, 0x3f803f80
v_mov_b32 v123, 0x3f803f80
s_waitcnt lgkmcnt(0)
v_pk_add_f32 v[196:197], v[196:197], v[204:205]
v_pk_add_f32 v[198:199], v[198:199], v[206:207]
v_pk_add_f32 v[200:201], v[200:201], v[208:209]
v_pk_add_f32 v[202:203], v[202:203], v[210:211]
v_pk_add_f32 v[196:197], v[196:197], v[236:237]
v_pk_add_f32 v[198:199], v[198:199], v[238:239]
v_pk_add_f32 v[200:201], v[200:201], v[240:241]
v_pk_add_f32 v[202:203], v[202:203], v[242:243]
v_cvt_pk_bf16_f32 v212, v196, v197
v_cvt_pk_bf16_f32 v213, v198, v199
v_cvt_pk_bf16_f32 v214, v200, v201
v_cvt_pk_bf16_f32 v215, v202, v203
global_store_dwordx4 v46, v[212:215], s[50:51] sc1
s_add_u32 m0, s60, 0
s_nop 0
global_load_lds_dwordx4 v21, s[54:55] offset:0 sc1
global_load_lds_dwordx4 v21, s[54:55] offset:1024 sc1
global_load_lds_dwordx4 v21, s[54:55] offset:2048 sc1
global_load_lds_dwordx4 v21, s[54:55] offset:3072 sc1
s_add_u32 m0, s60, 4096
s_add_u32 s70, s54, 4096
s_addc_u32 s71, s55, 0
global_load_lds_dwordx4 v21, s[70:71] offset:0 sc1
global_load_lds_dwordx4 v21, s[70:71] offset:1024 sc1
global_load_lds_dwordx4 v21, s[70:71] offset:2048 sc1
global_load_lds_dwordx4 v21, s[70:71] offset:3072 sc1
s_add_u32 m0, s60, 8192
s_add_u32 s70, s54, 8192
s_addc_u32 s71, s55, 0
global_load_lds_dwordx4 v21, s[70:71] offset:0 sc1
global_load_lds_dwordx4 v21, s[70:71] offset:1024 sc1
s_waitcnt vmcnt(38)
v_mfma_f32_16x16x32_bf16 v[124:127], a[0:3], v[120:123], 0
global_load_dwordx4 a[140:143], v2, s[88:89] offset:1024 sc1
v_mov_b32 v62, 0xc0135761
v_mfma_f32_16x16x32_bf16 v[128:131], a[4:7], v[120:123], 0
v_mov_b32 v63, 0xc0135761
v_mov_b32 v36, v16
v_mfma_f32_16x16x32_bf16 v[132:135], a[8:11], v[120:123], 0
v_xor_b32 v37, 32, v16
v_add_u32 v38, 47904, v36
v_mfma_f32_16x16x32_bf16 v[124:127], a[12:15], v[120:123], v[124:127]
v_add_u32 v39, 47904, v37
v_add_u32 v12, s60, v16
v_mfma_f32_16x16x32_bf16 v[128:131], a[16:19], v[120:123], v[128:131]
v_xor_b32 v13, 32, v12
s_mul_i32 s67, s45, 5120
v_add_u32 v25, s67, v25
v_add_u32 v26, s67, v26
v_mfma_f32_16x16x32_bf16 v[132:135], a[20:23], v[120:123], v[132:135]
v_mfma_f32_16x16x32_bf16 v[124:127], a[24:27], v[120:123], v[124:127]
global_load_dwordx4 a[144:147], v2, s[88:89] offset:2048 sc1
v_add_u32 v7, 49152, v2
v_mfma_f32_16x16x32_bf16 v[128:131], a[28:31], v[120:123], v[128:131]
s_add_u32 s62, s54, 1310720
s_addc_u32 s63, s55, 0
v_mfma_f32_16x16x32_bf16 v[132:135], a[32:35], v[120:123], v[132:135]
s_add_u32 s92, s84, 2097152
s_addc_u32 s93, s85, 0
v_mfma_f32_16x16x32_bf16 v[124:127], a[36:39], v[120:123], v[124:127]
s_add_u32 s94, s84, 2112512
s_addc_u32 s95, s85, 0
v_mfma_f32_16x16x32_bf16 v[128:131], a[40:43], v[120:123], v[128:131]
global_load_dwordx4 a[148:151], v2, s[88:89] offset:3072 sc1
s_add_u32 s96, s84, 2127872
s_addc_u32 s97, s85, 0
v_mfma_f32_16x16x32_bf16 v[132:135], a[44:47], v[120:123], v[132:135]
s_add_u32 s98, s84, 2143232
s_addc_u32 s99, s85, 0
v_mfma_f32_16x16x32_bf16 v[124:127], a[48:51], v[120:123], v[124:127]
s_bitcmp1_b32 s3, 0
s_cselect_b64 s[22:23], 0, -1
v_mfma_f32_16x16x32_bf16 v[128:131], a[52:55], v[120:123], v[128:131]
s_mul_i32 s67, s46, 98304
v_mfma_f32_16x16x32_bf16 v[132:135], a[56:59], v[120:123], v[132:135]
s_add_u32 s67, s67, 13631488
s_mul_i32 s68, s3, 12288
v_mfma_f32_16x16x32_bf16 v[124:127], a[60:63], v[120:123], v[124:127]
global_load_dwordx4 a[152:155], v9, s[88:89] offset:-4096 sc1
s_add_u32 s68, s68, s67
v_mfma_f32_16x16x32_bf16 v[128:131], a[64:67], v[120:123], v[128:131]
s_add_u32 s8, s40, s68
s_addc_u32 s9, s41, 0
v_mfma_f32_16x16x32_bf16 v[132:135], a[68:71], v[120:123], v[132:135]
s_add_u32 s10, s8, 4096
s_addc_u32 s11, s9, 0
s_waitcnt vmcnt(33)
v_mfma_f32_16x16x32_bf16 v[124:127], a[72:75], v[120:123], v[124:127]
s_add_u32 s12, s8, 8192
s_addc_u32 s13, s9, 0
v_mfma_f32_16x16x32_bf16 v[128:131], a[76:79], v[120:123], v[128:131]
s_add_u32 s48, s8, 3145728
s_addc_u32 s49, s9, 0
v_mfma_f32_16x16x32_bf16 v[132:135], a[80:83], v[120:123], v[132:135]
s_waitcnt vmcnt(29)
v_mfma_f32_16x16x32_bf16 v[124:127], a[84:87], v[120:123], v[124:127]
global_load_dwordx4 a[156:159], v9, s[88:89] offset:-3072 sc1
s_add_u32 s50, s8, 3149824
s_addc_u32 s51, s9, 0
v_mfma_f32_16x16x32_bf16 v[128:131], a[88:91], v[120:123], v[128:131]
s_add_u32 s52, s8, 3153920
s_addc_u32 s53, s9, 0
v_mfma_f32_16x16x32_bf16 v[132:135], a[92:95], v[120:123], v[132:135]
s_waitcnt vmcnt(25)
v_mfma_f32_16x16x32_bf16 v[124:127], a[96:99], v[120:123], v[124:127]
s_mul_i32 s68, s45, 6144
s_add_u32 s68, s68, s67
v_mfma_f32_16x16x32_bf16 v[128:131], a[100:103], v[120:123], v[128:131]
global_load_dwordx4 a[160:163], v9, s[88:89] offset:-2048 sc1
s_add_u32 s56, s40, s68
s_addc_u32 s57, s41, 0
v_mfma_f32_16x16x32_bf16 v[132:135], a[104:107], v[120:123], v[132:135]
s_waitcnt vmcnt(22)
v_mfma_f32_16x16x32_bf16 v[124:127], a[108:111], v[120:123], v[124:127]
s_mul_i32 s67, s46, 40960
s_mul_i32 s68, s45, 160
v_mfma_f32_16x16x32_bf16 v[128:131], a[112:115], v[120:123], v[128:131]
s_add_u32 s67, s67, s68
s_add_u32 s16, s36, s67
s_addc_u32 s17, s37, 0
v_mfma_f32_16x16x32_bf16 v[132:135], a[116:119], v[120:123], v[132:135]
s_waitcnt vmcnt(19)
v_mfma_f32_16x16x32_bf16 v[124:127], a[120:123], v[120:123], v[124:127]
global_load_dwordx4 a[164:167], v9, s[88:89] offset:-1024 sc1
s_add_u32 s0, s40, 131072
s_addc_u32 s1, s41, 0
v_mfma_f32_16x16x32_bf16 v[128:131], a[124:127], v[120:123], v[128:131]
s_mov_b32 s26, 0xbdd2d3e8
v_mfma_f32_16x16x32_bf16 v[132:135], a[128:131], v[120:123], v[132:135]
s_mov_b32 s27, 0xbdd2d3e8
s_mov_b32 s6, 0
s_waitcnt vmcnt(7)
L26_stage:
s_barrier
ds_read_b64_tr_b16 v[88:89], v12 offset:0
ds_read_b64_tr_b16 v[90:91], v12 offset:256
ds_read_b64_tr_b16 v[92:93], v13 offset:0
ds_read_b64_tr_b16 v[94:95], v13 offset:256
ds_read_b64_tr_b16 v[96:97], v12 offset:2048
ds_read_b64_tr_b16 v[98:99], v12 offset:2304
ds_read_b64_tr_b16 v[100:101], v13 offset:2048
ds_read_b64_tr_b16 v[102:103], v13 offset:2304
ds_read_b64_tr_b16 v[104:105], v12 offset:4096
ds_read_b64_tr_b16 v[106:107], v12 offset:4352
ds_read_b64_tr_b16 v[108:109], v13 offset:4096
ds_read_b64_tr_b16 v[110:111], v13 offset:4352
s_waitcnt lgkmcnt(8)
v_mfma_f32_16x16x32_bf16 v[136:139], v[120:123], v[88:91], 0
ds_read_b64_tr_b16 v[112:113], v12 offset:6144
global_load_dwordx4 v[44:47], v30, s[0:1] sc1
v_mfma_f32_16x16x32_bf16 v[140:143], v[88:91], v[88:91], 0
ds_read_b64_tr_b16 v[114:115], v12 offset:6400
global_load_dwordx4 a[168:171], v9, s[88:89] offset:0 sc1
v_mfma_f32_16x16x32_bf16 v[144:147], v[120:123], v[92:95], 0
ds_read_b64_tr_b16 v[116:117], v13 offset:6144
v_mfma_f32_16x16x32_bf16 v[148:151], v[92:95], v[92:95], 0
ds_read_b64_tr_b16 v[118:119], v13 offset:6400
s_waitcnt lgkmcnt(8)
v_mfma_f32_16x16x32_bf16 v[136:139], v[120:123], v[96:99], v[136:139]
ds_read_b64_tr_b16 v[88:89], v12 offset:8192
v_mfma_f32_16x16x32_bf16 v[140:143], v[96:99], v[96:99], v[140:143]
ds_read_b64_tr_b16 v[90:91], v12 offset:8448
global_load_dwordx4 a[172:175], v9, s[88:89] offset:1024 sc1
v_mfma_f32_16x16x32_bf16 v[144:147], v[120:123], v[100:103], v[144:147]
ds_read_b64_tr_b16 v[92:93], v13 offset:8192
v_mfma_f32_16x16x32_bf16 v[148:151], v[100:103], v[100:103], v[148:151]
ds_read_b64_tr_b16 v[94:95], v13 offset:8448
s_waitcnt lgkmcnt(8)
v_mfma_f32_16x16x32_bf16 v[136:139], v[120:123], v[104:107], v[136:139]
ds_read_b64_tr_b16 v[96:97], v36 offset:0
v_mfma_f32_16x16x32_bf16 v[140:143], v[104:107], v[104:107], v[140:143]
ds_read_b64_tr_b16 v[98:99], v36 offset:256
v_mfma_f32_16x16x32_bf16 v[144:147], v[120:123], v[108:111], v[144:147]
ds_read_b64_tr_b16 v[100:101], v37 offset:0
global_load_dwordx4 a[176:179], v9, s[88:89] offset:2048 sc1
v_mfma_f32_16x16x32_bf16 v[148:151], v[108:111], v[108:111], v[148:151]
ds_read_b64_tr_b16 v[102:103], v37 offset:256
s_waitcnt lgkmcnt(8)
v_mfma_f32_16x16x32_bf16 v[136:139], v[120:123], v[112:115], v[136:139]
ds_read_b64_tr_b16 v[104:105], v36 offset:2048
v_mfma_f32_16x16x32_bf16 v[140:143], v[112:115], v[112:115], v[140:143]
ds_read_b64_tr_b16 v[106:107], v36 offset:2304
v_mfma_f32_16x16x32_bf16 v[144:147], v[120:123], v[116:119], v[144:147]
ds_read_b64_tr_b16 v[108:109], v37 offset:2048
v_mfma_f32_16x16x32_bf16 v[148:151], v[116:119], v[116:119], v[148:151]
ds_read_b64_tr_b16 v[110:111], v37 offset:2304
s_waitcnt lgkmcnt(8)
v_mfma_f32_16x16x32_bf16 v[136:139], v[120:123], v[88:91], v[136:139]
ds_read_b64_tr_b16 v[112:113], v36 offset:4096
global_load_dwordx4 a[180:183], v2, s[90:91] offset:-4096 sc1
v_mfma_f32_16x16x32_bf16 v[140:143], v[88:91], v[88:91], v[140:143]
ds_read_b64_tr_b16 v[114:115], v36 offset:4352
v_mfma_f32_16x16x32_bf16 v[144:147], v[120:123], v[92:95], v[144:147]
ds_read_b64_tr_b16 v[116:117], v37 offset:4096
v_mfma_f32_16x16x32_bf16 v[148:151], v[92:95], v[92:95], v[148:151]
ds_read_b64_tr_b16 v[118:119], v37 offset:4352
s_waitcnt lgkmcnt(8)
v_mfma_f32_16x16x32_bf16 v[64:67], a[0:3], v[96:99], 0
ds_read_b64_tr_b16 v[88:89], v36 offset:6144
global_load_dwordx4 a[184:187], v2, s[90:91] offset:-3072 sc1
v_mfma_f32_16x16x32_bf16 v[68:71], a[4:7], v[96:99], 0
ds_read_b64_tr_b16 v[90:91], v36 offset:6400
v_mfma_f32_16x16x32_bf16 v[72:75], a[8:11], v[96:99], 0
ds_read_b64_tr_b16 v[92:93], v37 offset:6144
v_mfma_f32_16x16x32_bf16 v[76:79], a[0:3], v[100:103], 0
ds_read_b64_tr_b16 v[94:95], v37 offset:6400
v_lshrrev_b32 v4, 4, v2
v_mfma_f32_16x16x32_bf16 v[80:83], a[4:7], v[100:103], 0
v_and_b32 v4, 3, v4
v_cmp_eq_u32 vcc, 1, v4
s_nop 1
v_cndmask_b32 v140, v140, v141, vcc
v_cndmask_b32 v148, v148, v149, vcc
v_mfma_f32_16x16x32_bf16 v[84:87], a[8:11], v[100:103], 0
s_waitcnt lgkmcnt(8)
v_mfma_f32_16x16x32_bf16 v[64:67], a[12:15], v[104:107], v[64:67]
ds_read_b64_tr_b16 v[96:97], v36 offset:8192
v_mfma_f32_16x16x32_bf16 v[68:71], a[16:19], v[104:107], v[68:71]
ds_read_b64_tr_b16 v[98:99], v36 offset:8448
global_load_dwordx4 a[188:191], v2, s[90:91] offset:-2048 sc1
v_mfma_f32_16x16x32_bf16 v[72:75], a[20:23], v[104:107], v[72:75]
ds_read_b64_tr_b16 v[100:101], v37 offset:8192
v_cmp_eq_u32 vcc, 2, v4
s_nop 1
v_cndmask_b32 v140, v140, v142, vcc
v_cndmask_b32 v148, v148, v150, vcc
v_mfma_f32_16x16x32_bf16 v[76:79], a[12:15], v[108:111], v[76:79]
ds_read_b64_tr_b16 v[102:103], v37 offset:8448
v_mfma_f32_16x16x32_bf16 v[80:83], a[16:19], v[108:111], v[80:83]
global_load_dwordx4 a[192:195], v2, s[90:91] offset:-1024 sc1
v_mfma_f32_16x16x32_bf16 v[84:87], a[20:23], v[108:111], v[84:87]
v_cmp_eq_u32 vcc, 3, v4
s_nop 1
v_cndmask_b32 v140, v140, v143, vcc
v_cndmask_b32 v148, v148, v151, vcc
s_waitcnt lgkmcnt(8)
v_mfma_f32_16x16x32_bf16 v[64:67], a[24:27], v[112:115], v[64:67]
ds_read_b64_tr_b16 v[104:105], v36 offset:10240
v_mfma_f32_16x16x32_bf16 v[68:71], a[28:31], v[112:115], v[68:71]
ds_read_b64_tr_b16 v[106:107], v36 offset:10496
v_mfma_f32_16x16x32_bf16 v[72:75], a[32:35], v[112:115], v[72:75]
ds_read_b64_tr_b16 v[108:109], v37 offset:10240
v_mov_b32 v137, v140
v_mfma_f32_16x16x32_bf16 v[76:79], a[24:27], v[116:119], v[76:79]
ds_read_b64_tr_b16 v[110:111], v37 offset:10496
global_load_dwordx4 a[196:199], v2, s[90:91] offset:0 sc1
v_mfma_f32_16x16x32_bf16 v[80:83], a[28:31], v[116:119], v[80:83]
ds_write_b64 v17, v[136:137] offset:0
v_mfma_f32_16x16x32_bf16 v[84:87], a[32:35], v[116:119], v[84:87]
v_mov_b32 v145, v148
s_waitcnt lgkmcnt(9)
v_mfma_f32_16x16x32_bf16 v[64:67], a[36:39], v[88:91], v[64:67]
ds_read_b64_tr_b16 v[112:113], v36 offset:12288
ds_write_b64 v17, v[144:145] offset:512
v_mfma_f32_16x16x32_bf16 v[68:71], a[40:43], v[88:91], v[68:71]
ds_read_b64_tr_b16 v[114:115], v36 offset:12544
v_mfma_f32_16x16x32_bf16 v[72:75], a[44:47], v[88:91], v[72:75]
ds_read_b64_tr_b16 v[116:117], v37 offset:12288
global_load_dwordx4 a[200:203], v2, s[90:91] offset:1024 sc1
v_mfma_f32_16x16x32_bf16 v[76:79], a[36:39], v[92:95], v[76:79]
ds_read_b64_tr_b16 v[118:119], v37 offset:12544
s_waitcnt lgkmcnt(3)
s_barrier
v_mfma_f32_16x16x32_bf16 v[80:83], a[40:43], v[92:95], v[80:83]
ds_read_b128 v[136:139], v18 offset:0
v_mfma_f32_16x16x32_bf16 v[84:87], a[44:47], v[92:95], v[84:87]
ds_read_b128 v[140:143], v18 offset:16
s_waitcnt lgkmcnt(12)
v_mfma_f32_16x16x32_bf16 v[64:67], a[48:51], v[96:99], v[64:67]
ds_read_b64_tr_b16 v[88:89], v36 offset:14336
ds_read_b128 v[144:147], v18 offset:512
v_mfma_f32_16x16x32_bf16 v[68:71], a[52:55], v[96:99], v[68:71]
ds_read_b64_tr_b16 v[90:91], v36 offset:14592
global_load_dwordx4 a[204:207], v2, s[90:91] offset:2048 sc1
v_mfma_f32_16x16x32_bf16 v[72:75], a[56:59], v[96:99], v[72:75]
ds_read_b64_tr_b16 v[92:93], v37 offset:14336
ds_read_b128 v[148:151], v18 offset:528
v_mfma_f32_16x16x32_bf16 v[76:79], a[48:51], v[100:103], v[76:79]
ds_read_b64_tr_b16 v[94:95], v37 offset:14592
v_mfma_f32_16x16x32_bf16 v[80:83], a[52:55], v[100:103], v[80:83]
s_waitcnt lgkmcnt(1)
v_add_f32 v136, v136, v138
v_mfma_f32_16x16x32_bf16 v[84:87], a[56:59], v[100:103], v[84:87]
v_add_f32 v140, v140, v142
s_waitcnt lgkmcnt(14)
v_mfma_f32_16x16x32_bf16 v[64:67], a[60:63], v[104:107], v[64:67]
ds_read_b64_tr_b16 v[96:97], v36 offset:16384
global_load_dwordx4 a[208:211], v2, s[90:91] offset:3072 sc1
v_mfma_f32_16x16x32_bf16 v[68:71], a[64:67], v[104:107], v[68:71]
ds_read_b64_tr_b16 v[98:99], v36 offset:16640
v_add_f32 v137, v137, v139
v_mfma_f32_16x16x32_bf16 v[72:75], a[68:71], v[104:107], v[72:75]
ds_read_b64_tr_b16 v[100:101], v37 offset:16384
v_add_f32 v141, v141, v143
v_mfma_f32_16x16x32_bf16 v[76:79], a[60:63], v[108:111], v[76:79]
ds_read_b64_tr_b16 v[102:103], v37 offset:16640
v_add_f32 v40, v136, v140
v_mfma_f32_16x16x32_bf16 v[80:83], a[64:67], v[108:111], v[80:83]
v_add_f32 v41, v137, v141
v_add_f32 v144, v144, v146
v_mfma_f32_16x16x32_bf16 v[84:87], a[68:71], v[108:111], v[84:87]
global_load_dwordx4 a[212:215], v9, s[90:91] offset:-4096 sc1
s_waitcnt lgkmcnt(12)
v_mfma_f32_16x16x32_bf16 v[64:67], a[72:75], v[112:115], v[64:67]
ds_read_b64_tr_b16 v[104:105], v36 offset:18432
v_add_f32 v148, v148, v150
v_mfma_f32_16x16x32_bf16 v[68:71], a[76:79], v[112:115], v[68:71]
ds_read_b64_tr_b16 v[106:107], v36 offset:18688
v_add_f32 v145, v145, v147
v_mfma_f32_16x16x32_bf16 v[72:75], a[80:83], v[112:115], v[72:75]
ds_read_b64_tr_b16 v[108:109], v37 offset:18432
v_add_f32 v149, v149, v151
v_mfma_f32_16x16x32_bf16 v[76:79], a[72:75], v[116:119], v[76:79]
ds_read_b64_tr_b16 v[110:111], v37 offset:18688
v_add_f32 v42, v144, v148
v_mfma_f32_16x16x32_bf16 v[80:83], a[76:79], v[116:119], v[80:83]
global_load_dwordx4 a[216:219], v9, s[90:91] offset:-3072 sc1
v_add_f32 v43, v145, v149
v_mfma_f32_16x16x32_bf16 v[84:87], a[80:83], v[116:119], v[84:87]
v_cmp_u_f32 vcc, v40, v42
s_cbranch_vccnz L27_redo
L28_go:
s_nop 0
s_waitcnt lgkmcnt(8)
v_mfma_f32_16x16x32_bf16 v[64:67], a[84:87], v[88:91], v[64:67]
ds_read_b64_tr_b16 v[112:113], v36 offset:20480
v_mfma_f32_16x16x32_bf16 v[68:71], a[88:91], v[88:91], v[68:71]
ds_read_b64_tr_b16 v[114:115], v36 offset:20736
v_mfma_f32_16x16x32_bf16 v[72:75], a[92:95], v[88:91], v[72:75]
ds_read_b64_tr_b16 v[116:117], v37 offset:20480
v_mul_f32 v40, 0x3acccccd, v40
v_mfma_f32_16x16x32_bf16 v[76:79], a[84:87], v[92:95], v[76:79]
ds_read_b64_tr_b16 v[118:119], v37 offset:20736
global_load_dwordx4 a[220:223], v9, s[90:91] offset:-2048 sc1
v_mfma_f32_16x16x32_bf16 v[80:83], a[88:91], v[92:95], v[80:83]
v_mul_f32 v42, 0x3acccccd, v42
v_mul_f32 v41, 0x3acccccd, v41
v_mfma_f32_16x16x32_bf16 v[84:87], a[92:95], v[92:95], v[84:87]
v_mul_f32 v43, 0x3acccccd, v43
s_waitcnt lgkmcnt(8)
v_mfma_f32_16x16x32_bf16 v[64:67], a[96:99], v[96:99], v[64:67]
ds_read_b64_tr_b16 v[88:89], v36 offset:22528
v_fma_f32 v41, -v40, v40, v41
v_mfma_f32_16x16x32_bf16 v[68:71], a[100:103], v[96:99], v[68:71]
ds_read_b64_tr_b16 v[90:91], v36 offset:22784
v_fma_f32 v43, -v42, v42, v43
v_mfma_f32_16x16x32_bf16 v[72:75], a[104:107], v[96:99], v[72:75]
ds_read_b64_tr_b16 v[92:93], v37 offset:22528
global_load_dwordx4 a[224:227], v9, s[90:91] offset:-1024 sc1
v_mfma_f32_16x16x32_bf16 v[76:79], a[96:99], v[100:103], v[76:79]
ds_read_b64_tr_b16 v[94:95], v37 offset:22784
v_max_f32 v41, 0, v41
v_mfma_f32_16x16x32_bf16 v[80:83], a[100:103], v[100:103], v[80:83]
v_max_f32 v43, 0, v43
v_cvt_pk_bf16_f32 v4, v40, v40
v_mfma_f32_16x16x32_bf16 v[84:87], a[104:107], v[100:103], v[84:87]
v_cvt_pk_bf16_f32 v5, v42, v42
s_waitcnt lgkmcnt(8)
v_mfma_f32_16x16x32_bf16 v[64:67], a[108:111], v[104:107], v[64:67]
ds_read_b64_tr_b16 v[96:97], v36 offset:24576
v_cvt_pk_bf16_f32 v41, v41, v41
v_mfma_f32_16x16x32_bf16 v[68:71], a[112:115], v[104:107], v[68:71]
ds_read_b64_tr_b16 v[98:99], v36 offset:24832
global_load_dwordx4 a[228:231], v9, s[90:91] offset:0 sc1
v_mfma_f32_16x16x32_bf16 v[72:75], a[116:119], v[104:107], v[72:75]
ds_read_b64_tr_b16 v[100:101], v37 offset:24576
v_cvt_pk_bf16_f32 v43, v43, v43
v_mfma_f32_16x16x32_bf16 v[76:79], a[108:111], v[108:111], v[76:79]
ds_read_b64_tr_b16 v[102:103], v37 offset:24832
v_lshlrev_b32 v41, 16, v41
v_mfma_f32_16x16x32_bf16 v[80:83], a[112:115], v[108:111], v[80:83]
v_lshlrev_b32 v43, 16, v43
v_add_f32 v41, 0x3727c5ac, v41
v_mfma_f32_16x16x32_bf16 v[84:87], a[116:119], v[108:111], v[84:87]
v_add_f32 v43, 0x3727c5ac, v43
s_waitcnt lgkmcnt(8)
v_mfma_f32_16x16x32_bf16 v[64:67], a[120:123], v[112:115], v[64:67]
ds_read_b64_tr_b16 v[104:105], v36 offset:26624
global_load_dwordx4 a[232:235], v9, s[90:91] offset:1024 sc1
v_mfma_f32_16x16x32_bf16 v[68:71], a[124:127], v[112:115], v[68:71]
ds_read_b64_tr_b16 v[106:107], v36 offset:26880
v_cvt_pk_bf16_f32 v41, v41, v41
v_mfma_f32_16x16x32_bf16 v[72:75], a[128:131], v[112:115], v[72:75]
ds_read_b64_tr_b16 v[108:109], v37 offset:26624
v_cvt_pk_bf16_f32 v43, v43, v43
v_mfma_f32_16x16x32_bf16 v[76:79], a[120:123], v[116:119], v[76:79]
ds_read_b64_tr_b16 v[110:111], v37 offset:26880
v_lshlrev_b32 v41, 16, v41
v_mfma_f32_16x16x32_bf16 v[80:83], a[124:127], v[116:119], v[80:83]
v_lshlrev_b32 v43, 16, v43
v_sqrt_f32 v41, v41
v_mfma_f32_16x16x32_bf16 v[84:87], a[128:131], v[116:119], v[84:87]
s_waitcnt lgkmcnt(8)
s_waitcnt vmcnt(24)
v_mfma_f32_16x16x32_bf16 v[64:67], a[132:135], v[88:91], v[64:67]
ds_read_b64_tr_b16 v[112:113], v36 offset:28672
v_mfma_f32_16x16x32_bf16 v[68:71], a[136:139], v[88:91], v[68:71]
ds_read_b64_tr_b16 v[114:115], v36 offset:28928
global_load_dwordx4 a[236:239], v9, s[90:91] offset:2048 sc1
v_mfma_f32_16x16x32_bf16 v[72:75], a[140:143], v[88:91], v[72:75]
ds_read_b64_tr_b16 v[116:117], v37 offset:28672
v_sqrt_f32 v43, v43
v_mfma_f32_16x16x32_bf16 v[76:79], a[132:135], v[92:95], v[76:79]
ds_read_b64_tr_b16 v[118:119], v37 offset:28928
v_mfma_f32_16x16x32_bf16 v[80:83], a[136:139], v[92:95], v[80:83]
s_add_u32 m0, s60, 47904
s_nop 0
global_load_lds_dwordx4 v21, s[62:63] offset:0 sc1
v_mfma_f32_16x16x32_bf16 v[84:87], a[140:143], v[92:95], v[84:87]
s_waitcnt lgkmcnt(8)
s_waitcnt vmcnt(23)
v_mfma_f32_16x16x32_bf16 v[64:67], a[144:147], v[96:99], v[64:67]
ds_read_b64_tr_b16 v[88:89], v36 offset:30720
v_mfma_f32_16x16x32_bf16 v[68:71], a[148:151], v[96:99], v[68:71]
ds_read_b64_tr_b16 v[90:91], v36 offset:30976
global_load_lds_dwordx4 v21, s[62:63] offset:1024 sc1
v_mfma_f32_16x16x32_bf16 v[72:75], a[152:155], v[96:99], v[72:75]
ds_read_b64_tr_b16 v[92:93], v37 offset:30720
v_cvt_pk_bf16_f32 v41, v41, v41
v_mfma_f32_16x16x32_bf16 v[76:79], a[144:147], v[100:103], v[76:79]
ds_read_b64_tr_b16 v[94:95], v37 offset:30976
v_cvt_pk_bf16_f32 v43, v43, v43
v_mfma_f32_16x16x32_bf16 v[80:83], a[148:151], v[100:103], v[80:83]
global_load_lds_dwordx4 v21, s[62:63] offset:2048 sc1
v_lshlrev_b32 v41, 16, v41
v_mfma_f32_16x16x32_bf16 v[84:87], a[152:155], v[100:103], v[84:87]
s_waitcnt lgkmcnt(8)
s_waitcnt vmcnt(22)
v_mfma_f32_16x16x32_bf16 v[64:67], a[156:159], v[104:107], v[64:67]
ds_read_b64_tr_b16 v[96:97], v36 offset:32768
v_lshlrev_b32 v43, 16, v43
v_mfma_f32_16x16x32_bf16 v[68:71], a[160:163], v[104:107], v[68:71]
ds_read_b64_tr_b16 v[98:99], v36 offset:33024
global_load_lds_dwordx4 v21, s[62:63] offset:3072 sc1
v_mfma_f32_16x16x32_bf16 v[72:75], a[164:167], v[104:107], v[72:75]
ds_read_b64_tr_b16 v[100:101], v37 offset:32768
v_rcp_f32 v32, v41
v_mfma_f32_16x16x32_bf16 v[76:79], a[156:159], v[108:111], v[76:79]
ds_read_b64_tr_b16 v[102:103], v37 offset:33024
v_mfma_f32_16x16x32_bf16 v[80:83], a[160:163], v[108:111], v[80:83]
s_add_u32 m0, s60, 52000
s_add_u32 s70, s62, 4096
s_addc_u32 s71, s63, 0
global_load_lds_dwordx4 v21, s[70:71] offset:0 sc1
v_mfma_f32_16x16x32_bf16 v[84:87], a[164:167], v[108:111], v[84:87]
s_waitcnt lgkmcnt(8)
s_waitcnt vmcnt(20)
v_mfma_f32_16x16x32_bf16 v[64:67], a[168:171], v[112:115], v[64:67]
ds_read_b64_tr_b16 v[104:105], v36 offset:34816
v_mfma_f32_16x16x32_bf16 v[68:71], a[172:175], v[112:115], v[68:71]
ds_read_b64_tr_b16 v[106:107], v36 offset:35072
v_mfma_f32_16x16x32_bf16 v[72:75], a[176:179], v[112:115], v[72:75]
ds_read_b64_tr_b16 v[108:109], v37 offset:34816
global_load_lds_dwordx4 v21, s[70:71] offset:1024 sc1
v_mfma_f32_16x16x32_bf16 v[76:79], a[168:171], v[116:119], v[76:79]
ds_read_b64_tr_b16 v[110:111], v37 offset:35072
v_rcp_f32 v33, v43
v_mfma_f32_16x16x32_bf16 v[80:83], a[172:175], v[116:119], v[80:83]
global_load_lds_dwordx4 v21, s[70:71] offset:2048 sc1
v_mfma_f32_16x16x32_bf16 v[84:87], a[176:179], v[116:119], v[84:87]
s_waitcnt lgkmcnt(8)
s_waitcnt vmcnt(19)
v_mfma_f32_16x16x32_bf16 v[64:67], a[180:183], v[88:91], v[64:67]
ds_read_b64_tr_b16 v[112:113], v36 offset:36864
v_and_b32 v4, 0xffff0000, v4
v_mfma_f32_16x16x32_bf16 v[68:71], a[184:187], v[88:91], v[68:71]
ds_read_b64_tr_b16 v[114:115], v36 offset:37120
global_load_lds_dwordx4 v21, s[70:71] offset:3072 sc1
v_mfma_f32_16x16x32_bf16 v[72:75], a[188:191], v[88:91], v[72:75]
ds_read_b64_tr_b16 v[116:117], v37 offset:36864
v_and_b32 v5, 0xffff0000, v5
v_mfma_f32_16x16x32_bf16 v[76:79], a[180:183], v[92:95], v[76:79]
ds_read_b64_tr_b16 v[118:119], v37 offset:37120
v_mul_f32 v34, -v4, v32
v_mfma_f32_16x16x32_bf16 v[80:83], a[184:187], v[92:95], v[80:83]
s_add_u32 m0, s60, 56096
s_add_u32 s70, s62, 8192
s_addc_u32 s71, s63, 0
global_load_lds_dwordx4 v21, s[70:71] offset:0 sc1
v_mfma_f32_16x16x32_bf16 v[84:87], a[188:191], v[92:95], v[84:87]
s_waitcnt lgkmcnt(8)
s_waitcnt vmcnt(18)
v_mfma_f32_16x16x32_bf16 v[64:67], a[192:195], v[96:99], v[64:67]
ds_read_b64_tr_b16 v[88:89], v36 offset:38912
v_mfma_f32_16x16x32_bf16 v[68:71], a[196:199], v[96:99], v[68:71]
ds_read_b64_tr_b16 v[90:91], v36 offset:39168
v_mfma_f32_16x16x32_bf16 v[72:75], a[200:203], v[96:99], v[72:75]
ds_read_b64_tr_b16 v[92:93], v37 offset:38912
global_load_lds_dwordx4 v21, s[70:71] offset:1024 sc1
v_mfma_f32_16x16x32_bf16 v[76:79], a[192:195], v[100:103], v[76:79]
ds_read_b64_tr_b16 v[94:95], v37 offset:39168
v_mul_f32 v35, -v5, v33
v_mfma_f32_16x16x32_bf16 v[80:83], a[196:199], v[100:103], v[80:83]
s_waitcnt vmcnt(28)
s_mov_b32 s64, 0
v_xor_b32 v44, v44, v8
v_xor_b32 v45, v45, v8
v_xor_b32 v46, v46, v8
v_xor_b32 v47, v47, v8
v_or3_b32 v44, v44, v45, v46
v_or_b32 v44, v44, v47
v_cmp_ne_u32 vcc, 0, v44
s_cbranch_vccnz L24_w2w
L25_w2ok:
v_mfma_f32_16x16x32_bf16 v[84:87], a[200:203], v[100:103], v[84:87]
s_waitcnt lgkmcnt(8)
s_waitcnt vmcnt(16)
v_mfma_f32_16x16x32_bf16 v[64:67], a[204:207], v[104:107], v[64:67]
v_mfma_f32_16x16x32_bf16 v[68:71], a[208:211], v[104:107], v[68:71]
v_lshlrev_b32 v160, 16, v48
v_and_b32 v161, 0xffff0000, v48
v_mfma_f32_16x16x32_bf16 v[72:75], a[212:215], v[104:107], v[72:75]
v_lshlrev_b32 v162, 16, v49
v_and_b32 v163, 0xffff0000, v49
v_mfma_f32_16x16x32_bf16 v[76:79], a[204:207], v[108:111], v[76:79]
global_load_dwordx4 v[172:175], v2, s[92:93] offset:-4096 sc1
v_lshlrev_b32 v164, 16, v50
v_mfma_f32_16x16x32_bf16 v[80:83], a[208:211], v[108:111], v[80:83]
v_and_b32 v165, 0xffff0000, v50
v_lshlrev_b32 v166, 16, v51
v_mfma_f32_16x16x32_bf16 v[84:87], a[212:215], v[108:111], v[84:87]
s_waitcnt lgkmcnt(4)
s_waitcnt vmcnt(14)
v_mfma_f32_16x16x32_bf16 v[64:67], a[216:219], v[112:115], v[64:67]
v_and_b32 v167, 0xffff0000, v51
v_lshlrev_b32 v168, 16, v52
v_mfma_f32_16x16x32_bf16 v[68:71], a[220:223], v[112:115], v[68:71]
v_and_b32 v169, 0xffff0000, v52
v_lshlrev_b32 v170, 16, v53
v_mfma_f32_16x16x32_bf16 v[72:75], a[224:227], v[112:115], v[72:75]
global_load_dwordx4 v[176:179], v2, s[92:93] offset:-3072 sc1
v_and_b32 v171, 0xffff0000, v53
v_mfma_f32_16x16x32_bf16 v[76:79], a[216:219], v[116:119], v[76:79]
v_mfma_f32_16x16x32_bf16 v[80:83], a[220:223], v[116:119], v[80:83]
v_mfma_f32_16x16x32_bf16 v[84:87], a[224:227], v[116:119], v[84:87]
s_waitcnt lgkmcnt(0)
s_waitcnt vmcnt(12)
v_mfma_f32_16x16x32_bf16 v[64:67], a[228:231], v[88:91], v[64:67]
v_mfma_f32_16x16x32_bf16 v[68:71], a[232:235], v[88:91], v[68:71]
global_load_dwordx4 v[180:183], v2, s[92:93] offset:-2048 sc1
v_mfma_f32_16x16x32_bf16 v[72:75], a[236:239], v[88:91], v[72:75]
v_mfma_f32_16x16x32_bf16 v[76:79], a[228:231], v[92:95], v[76:79]
v_mfma_f32_16x16x32_bf16 v[80:83], a[232:235], v[92:95], v[80:83]
v_mfma_f32_16x16x32_bf16 v[84:87], a[236:239], v[92:95], v[84:87]
s_waitcnt vmcnt(3)
s_barrier
ds_read_b64_tr_b16 v[88:89], v12 offset:47904
ds_read_b64_tr_b16 v[90:91], v12 offset:48160
ds_read_b64_tr_b16 v[92:93], v13 offset:47904
ds_read_b64_tr_b16 v[94:95], v13 offset:48160
ds_read_b64_tr_b16 v[96:97], v12 offset:49952
ds_read_b64_tr_b16 v[98:99], v12 offset:50208
ds_read_b64_tr_b16 v[100:101], v13 offset:49952
ds_read_b64_tr_b16 v[102:103], v13 offset:50208
ds_read_b64_tr_b16 v[104:105], v12 offset:52000
ds_read_b64_tr_b16 v[106:107], v12 offset:52256
ds_read_b64_tr_b16 v[108:109], v13 offset:52000
ds_read_b64_tr_b16 v[110:111], v13 offset:52256
v_mfma_f32_16x16x32_bf16 v[124:127], a[132:135], v[120:123], v[124:127]
global_load_dwordx4 v[184:187], v2, s[92:93] offset:-1024 sc1
v_mfma_f32_16x16x32_bf16 v[128:131], a[136:139], v[120:123], v[128:131]
v_mfma_f32_16x16x32_bf16 v[132:135], a[140:143], v[120:123], v[132:135]
v_mfma_f32_16x16x32_bf16 v[124:127], a[144:147], v[120:123], v[124:127]
v_mfma_f32_16x16x32_bf16 v[128:131], a[148:151], v[120:123], v[128:131]
v_mfma_f32_16x16x32_bf16 v[132:135], a[152:155], v[120:123], v[132:135]
global_load_dwordx4 v[188:191], v2, s[92:93] offset:0 sc1
v_mfma_f32_16x16x32_bf16 v[124:127], a[156:159], v[120:123], v[124:127]
v_mfma_f32_16x16x32_bf16 v[128:131], a[160:163], v[120:123], v[128:131]
v_mfma_f32_16x16x32_bf16 v[132:135], a[164:167], v[120:123], v[132:135]
s_waitcnt lgkmcnt(8)
v_mfma_f32_16x16x32_bf16 v[136:139], v[120:123], v[88:91], 0
ds_read_b64_tr_b16 v[112:113], v12 offset:54048
v_mfma_f32_16x16x32_bf16 v[140:143], v[88:91], v[88:91], 0
ds_read_b64_tr_b16 v[114:115], v12 offset:54304
global_load_dwordx4 v[192:195], v2, s[92:93] offset:1024 sc1
v_mfma_f32_16x16x32_bf16 v[144:147], v[120:123], v[92:95], 0
ds_read_b64_tr_b16 v[116:117], v13 offset:54048
v_mfma_f32_16x16x32_bf16 v[148:151], v[92:95], v[92:95], 0
ds_read_b64_tr_b16 v[118:119], v13 offset:54304
s_waitcnt lgkmcnt(8)
v_mfma_f32_16x16x32_bf16 v[136:139], v[120:123], v[96:99], v[136:139]
ds_read_b64_tr_b16 v[88:89], v12 offset:56096
v_mfma_f32_16x16x32_bf16 v[140:143], v[96:99], v[96:99], v[140:143]
ds_read_b64_tr_b16 v[90:91], v12 offset:56352
v_mfma_f32_16x16x32_bf16 v[144:147], v[120:123], v[100:103], v[144:147]
ds_read_b64_tr_b16 v[92:93], v13 offset:56096
global_load_dwordx4 v[196:199], v2, s[92:93] offset:2048 sc1
v_mfma_f32_16x16x32_bf16 v[148:151], v[100:103], v[100:103], v[148:151]
ds_read_b64_tr_b16 v[94:95], v13 offset:56352
s_waitcnt lgkmcnt(8)
v_mfma_f32_16x16x32_bf16 v[136:139], v[120:123], v[104:107], v[136:139]
v_mfma_f32_16x16x32_bf16 v[140:143], v[104:107], v[104:107], v[140:143]
v_mfma_f32_16x16x32_bf16 v[144:147], v[120:123], v[108:111], v[144:147]
v_mfma_f32_16x16x32_bf16 v[148:151], v[108:111], v[108:111], v[148:151]
global_load_dwordx4 v[200:203], v2, s[92:93] offset:3072 sc1
s_waitcnt lgkmcnt(4)
v_mfma_f32_16x16x32_bf16 v[136:139], v[120:123], v[112:115], v[136:139]
v_mfma_f32_16x16x32_bf16 v[140:143], v[112:115], v[112:115], v[140:143]
v_mfma_f32_16x16x32_bf16 v[144:147], v[120:123], v[116:119], v[144:147]
v_mfma_f32_16x16x32_bf16 v[148:151], v[116:119], v[116:119], v[148:151]
s_waitcnt lgkmcnt(0)
v_mfma_f32_16x16x32_bf16 v[136:139], v[120:123], v[88:91], v[136:139]
global_load_dwordx4 v[204:207], v9, s[92:93] offset:-4096 sc1
v_mfma_f32_16x16x32_bf16 v[140:143], v[88:91], v[88:91], v[140:143]
v_mfma_f32_16x16x32_bf16 v[144:147], v[120:123], v[92:95], v[144:147]
v_mfma_f32_16x16x32_bf16 v[148:151], v[92:95], v[92:95], v[148:151]
v_mfma_f32_16x16x32_bf16 v[124:127], a[168:171], v[120:123], v[124:127]
v_mfma_f32_16x16x32_bf16 v[128:131], a[172:175], v[120:123], v[128:131]
global_load_dwordx4 v[208:211], v9, s[92:93] offset:-3072 sc1
v_mfma_f32_16x16x32_bf16 v[132:135], a[176:179], v[120:123], v[132:135]
v_lshrrev_b32 v4, 4, v2
v_and_b32 v4, 3, v4
v_mfma_f32_16x16x32_bf16 v[124:127], a[180:183], v[120:123], v[124:127]
v_cmp_eq_u32 vcc, 1, v4
s_nop 1
v_cndmask_b32 v140, v140, v141, vcc
v_cndmask_b32 v148, v148, v149, vcc
v_mfma_f32_16x16x32_bf16 v[128:131], a[184:187], v[120:123], v[128:131]
v_cmp_eq_u32 vcc, 2, v4
s_nop 1
v_cndmask_b32 v140, v140, v142, vcc
v_cndmask_b32 v148, v148, v150, vcc
v_mfma_f32_16x16x32_bf16 v[132:135], a[188:191], v[120:123], v[132:135]
v_mfma_f32_16x16x32_bf16 v[124:127], a[192:195], v[120:123], v[124:127]
global_load_dwordx4 v[212:215], v9, s[92:93] offset:-2048 sc1
v_cmp_eq_u32 vcc, 3, v4
s_nop 1
v_cndmask_b32 v140, v140, v143, vcc
v_cndmask_b32 v148, v148, v151, vcc
v_mfma_f32_16x16x32_bf16 v[128:131], a[196:199], v[120:123], v[128:131]
v_mfma_f32_16x16x32_bf16 v[132:135], a[200:203], v[120:123], v[132:135]
v_mov_b32 v137, v140
ds_write_b64 v17, v[136:137] offset:0
v_mfma_f32_16x16x32_bf16 v[124:127], a[204:207], v[120:123], v[124:127]
v_mov_b32 v145, v148
v_mfma_f32_16x16x32_bf16 v[128:131], a[208:211], v[120:123], v[128:131]
ds_write_b64 v17, v[144:145] offset:512
v_mfma_f32_16x16x32_bf16 v[132:135], a[212:215], v[120:123], v[132:135]
global_load_dwordx4 v[216:219], v9, s[92:93] offset:-1024 sc1
v_mfma_f32_16x16x32_bf16 v[124:127], a[216:219], v[120:123], v[124:127]
v_mfma_f32_16x16x32_bf16 v[128:131], a[220:223], v[120:123], v[128:131]
v_mfma_f32_16x16x32_bf16 v[132:135], a[224:227], v[120:123], v[132:135]
v_mfma_f32_16x16x32_bf16 v[124:127], a[228:231], v[120:123], v[124:127]
v_mfma_f32_16x16x32_bf16 v[128:131], a[232:235], v[120:123], v[128:131]
global_load_dwordx4 v[220:223], v9, s[92:93] offset:0 sc1
v_mfma_f32_16x16x32_bf16 v[132:135], a[236:239], v[120:123], v[132:135]
s_nop 4
v_pk_fma_f32 v[136:137], v[124:125], v[34:35], v[160:161] op_sel:[0,0,0] op_sel_hi:[1,0,1]
v_pk_fma_f32 v[138:139], v[126:127], v[34:35], v[162:163] op_sel:[0,0,0] op_sel_hi:[1,0,1]
v_pk_fma_f32 v[140:141], v[128:129], v[34:35], v[164:165] op_sel:[0,0,0] op_sel_hi:[1,0,1]
v_pk_fma_f32 v[142:143], v[130:131], v[34:35], v[166:167] op_sel:[0,0,0] op_sel_hi:[1,0,1]
v_pk_fma_f32 v[144:145], v[132:133], v[34:35], v[168:169] op_sel:[0,0,0] op_sel_hi:[1,0,1]
v_pk_fma_f32 v[146:147], v[134:135], v[34:35], v[170:171] op_sel:[0,0,0] op_sel_hi:[1,0,1]
v_pk_fma_f32 v[64:65], v[64:65], v[32:33], v[136:137] op_sel:[0,0,0] op_sel_hi:[1,0,1]
v_pk_fma_f32 v[66:67], v[66:67], v[32:33], v[138:139] op_sel:[0,0,0] op_sel_hi:[1,0,1]
v_pk_fma_f32 v[68:69], v[68:69], v[32:33], v[140:141] op_sel:[0,0,0] op_sel_hi:[1,0,1]
v_pk_fma_f32 v[70:71], v[70:71], v[32:33], v[142:143] op_sel:[0,0,0] op_sel_hi:[1,0,1]
v_pk_fma_f32 v[72:73], v[72:73], v[32:33], v[144:145] op_sel:[0,0,0] op_sel_hi:[1,0,1]
v_pk_fma_f32 v[74:75], v[74:75], v[32:33], v[146:147] op_sel:[0,0,0] op_sel_hi:[1,0,1]
v_pk_fma_f32 v[148:149], v[124:125], v[34:35], v[160:161] op_sel:[0,1,0] op_sel_hi:[1,1,1]
v_pk_fma_f32 v[150:151], v[126:127], v[34:35], v[162:163] op_sel:[0,1,0] op_sel_hi:[1,1,1]
v_pk_fma_f32 v[152:153], v[128:129], v[34:35], v[164:165] op_sel:[0,1,0] op_sel_hi:[1,1,1]
v_pk_fma_f32 v[154:155], v[130:131], v[34:35], v[166:167] op_sel:[0,1,0] op_sel_hi:[1,1,1]
v_pk_fma_f32 v[156:157], v[132:133], v[34:35], v[168:169] op_sel:[0,1,0] op_sel_hi:[1,1,1]
v_pk_fma_f32 v[158:159], v[134:135], v[34:35], v[170:171] op_sel:[0,1,0] op_sel_hi:[1,1,1]
v_pk_fma_f32 v[76:77], v[76:77], v[32:33], v[148:149] op_sel:[0,1,0] op_sel_hi:[1,1,1]
v_pk_fma_f32 v[78:79], v[78:79], v[32:33], v[150:151] op_sel:[0,1,0] op_sel_hi:[1,1,1]
v_pk_fma_f32 v[80:81], v[80:81], v[32:33], v[152:153] op_sel:[0,1,0] op_sel_hi:[1,1,1]
v_pk_fma_f32 v[82:83], v[82:83], v[32:33], v[154:155] op_sel:[0,1,0] op_sel_hi:[1,1,1]
v_pk_fma_f32 v[84:85], v[84:85], v[32:33], v[156:157] op_sel:[0,1,0] op_sel_hi:[1,1,1]
v_pk_fma_f32 v[86:87], v[86:87], v[32:33], v[158:159] op_sel:[0,1,0] op_sel_hi:[1,1,1]
v_pk_mul_f32 v[88:89], v[64:65], v[64:65]
v_pk_mul_f32 v[90:91], v[66:67], v[66:67]
v_pk_mul_f32 v[92:93], v[68:69], v[68:69]
v_pk_mul_f32 v[94:95], v[70:71], v[70:71]
v_pk_mul_f32 v[96:97], v[72:73], v[72:73]
v_pk_mul_f32 v[98:99], v[74:75], v[74:75]
v_pk_mul_f32 v[100:101], v[76:77], v[76:77]
v_pk_mul_f32 v[102:103], v[78:79], v[78:79]
v_pk_mul_f32 v[104:105], v[80:81], v[80:81]
v_pk_mul_f32 v[106:107], v[82:83], v[82:83]
v_pk_mul_f32 v[108:109], v[84:85], v[84:85]
v_pk_mul_f32 v[110:111], v[86:87], v[86:87]
v_pk_fma_f32 v[88:89], v[88:89], s[26:27], v[62:63]
v_pk_fma_f32 v[90:91], v[90:91], s[26:27], v[62:63]
v_pk_fma_f32 v[92:93], v[92:93], s[26:27], v[62:63]
v_pk_fma_f32 v[94:95], v[94:95], s[26:27], v[62:63]
global_load_dwordx4 v[224:227], v9, s[92:93] offset:1024 sc1
global_load_dwordx4 v[228:231], v9, s[92:93] offset:2048 sc1
v_pk_fma_f32 v[96:97], v[96:97], s[26:27], v[62:63]
v_pk_fma_f32 v[98:99], v[98:99], s[26:27], v[62:63]
v_pk_fma_f32 v[100:101], v[100:101], s[26:27], v[62:63]
v_pk_fma_f32 v[102:103], v[102:103], s[26:27], v[62:63]
v_pk_fma_f32 v[104:105], v[104:105], s[26:27], v[62:63]
v_pk_fma_f32 v[106:107], v[106:107], s[26:27], v[62:63]
v_pk_fma_f32 v[108:109], v[108:109], s[26:27], v[62:63]
v_pk_fma_f32 v[110:111], v[110:111], s[26:27], v[62:63]
v_pk_mul_f32 v[88:89], v[88:89], v[64:65]
v_pk_mul_f32 v[90:91], v[90:91], v[66:67]
v_pk_mul_f32 v[92:93], v[92:93], v[68:69]
v_pk_mul_f32 v[94:95], v[94:95], v[70:71]
v_pk_mul_f32 v[96:97], v[96:97], v[72:73]
v_pk_mul_f32 v[98:99], v[98:99], v[74:75]
v_pk_mul_f32 v[100:101], v[100:101], v[76:77]
v_pk_mul_f32 v[102:103], v[102:103], v[78:79]
v_pk_mul_f32 v[104:105], v[104:105], v[80:81]
v_pk_mul_f32 v[106:107], v[106:107], v[82:83]
v_pk_mul_f32 v[108:109], v[108:109], v[84:85]
v_pk_mul_f32 v[110:111], v[110:111], v[86:87]
s_waitcnt lgkmcnt(0)
s_barrier
ds_read_b128 v[136:139], v18 offset:0
ds_read_b128 v[140:143], v18 offset:16
ds_read_b128 v[144:147], v18 offset:512
ds_read_b128 v[148:151], v18 offset:528
v_exp_f32 v88, v88
v_exp_f32 v89, v89
v_exp_f32 v90, v90
v_exp_f32 v91, v91
v_exp_f32 v92, v92
v_exp_f32 v93, v93
v_exp_f32 v94, v94
global_load_dwordx4 v[232:235], v2, s[94:95] offset:-4096 sc1
global_load_dwordx4 v[236:239], v2, s[94:95] offset:-3072 sc1
v_exp_f32 v95, v95
v_exp_f32 v96, v96
v_exp_f32 v97, v97
v_exp_f32 v98, v98
v_exp_f32 v99, v99
v_exp_f32 v100, v100
v_exp_f32 v101, v101
v_exp_f32 v102, v102
v_exp_f32 v103, v103
v_exp_f32 v104, v104
v_exp_f32 v105, v105
v_exp_f32 v106, v106
v_exp_f32 v107, v107
v_exp_f32 v108, v108
v_exp_f32 v109, v109
v_exp_f32 v110, v110
v_exp_f32 v111, v111
s_waitcnt lgkmcnt(0)
v_pk_add_f32 v[136:137], v[136:137], v[138:139]
v_pk_add_f32 v[140:141], v[140:141], v[142:143]
v_pk_add_f32 v[40:41], v[136:137], v[140:141]
v_pk_add_f32 v[144:145], v[144:145], v[146:147]
v_pk_add_f32 v[148:149], v[148:149], v[150:151]
global_load_dwordx4 v[240:243], v2, s[94:95] offset:-2048 sc1
global_load_dwordx4 v[244:247], v2, s[94:95] offset:-1024 sc1
v_pk_add_f32 v[42:43], v[144:145], v[148:149]
v_pk_add_f32 v[88:89], v[88:89], 1.0 op_sel_hi:[1,0]
v_pk_add_f32 v[90:91], v[90:91], 1.0 op_sel_hi:[1,0]
v_pk_add_f32 v[92:93], v[92:93], 1.0 op_sel_hi:[1,0]
v_pk_add_f32 v[94:95], v[94:95], 1.0 op_sel_hi:[1,0]
v_pk_add_f32 v[96:97], v[96:97], 1.0 op_sel_hi:[1,0]
v_pk_add_f32 v[98:99], v[98:99], 1.0 op_sel_hi:[1,0]
v_pk_add_f32 v[100:101], v[100:101], 1.0 op_sel_hi:[1,0]
v_pk_add_f32 v[102:103], v[102:103], 1.0 op_sel_hi:[1,0]
v_pk_add_f32 v[104:105], v[104:105], 1.0 op_sel_hi:[1,0]
v_pk_add_f32 v[106:107], v[106:107], 1.0 op_sel_hi:[1,0]
v_pk_add_f32 v[108:109], v[108:109], 1.0 op_sel_hi:[1,0]
v_pk_add_f32 v[110:111], v[110:111], 1.0 op_sel_hi:[1,0]
v_rcp_f32 v88, v88
v_rcp_f32 v89, v89
v_rcp_f32 v90, v90
v_rcp_f32 v91, v91
v_rcp_f32 v92, v92
v_rcp_f32 v93, v93
v_rcp_f32 v94, v94
v_rcp_f32 v95, v95
v_rcp_f32 v96, v96
v_rcp_f32 v97, v97
v_rcp_f32 v98, v98
v_rcp_f32 v99, v99
v_rcp_f32 v100, v100
v_rcp_f32 v101, v101
global_load_dwordx4 v[248:251], v2, s[94:95] offset:0 sc1
global_load_dwordx4 a[240:243], v2, s[94:95] offset:1024 sc1
v_rcp_f32 v102, v102
v_rcp_f32 v103, v103
v_rcp_f32 v104, v104
v_rcp_f32 v105, v105
v_rcp_f32 v106, v106
v_rcp_f32 v107, v107
v_rcp_f32 v108, v108
v_rcp_f32 v109, v109
v_rcp_f32 v110, v110
v_rcp_f32 v111, v111
v_pk_mul_f32 v[64:65], v[64:65], v[88:89]
v_pk_mul_f32 v[66:67], v[66:67], v[90:91]
v_pk_mul_f32 v[68:69], v[68:69], v[92:93]
v_pk_mul_f32 v[70:71], v[70:71], v[94:95]
v_pk_mul_f32 v[72:73], v[72:73], v[96:97]
v_pk_mul_f32 v[74:75], v[74:75], v[98:99]
v_pk_mul_f32 v[76:77], v[76:77], v[100:101]
v_pk_mul_f32 v[78:79], v[78:79], v[102:103]
v_pk_mul_f32 v[80:81], v[80:81], v[104:105]
v_pk_mul_f32 v[82:83], v[82:83], v[106:107]
v_pk_mul_f32 v[84:85], v[84:85], v[108:109]
v_pk_mul_f32 v[86:87], v[86:87], v[110:111]
ds_read_b64_tr_b16 v[88:89], v38 offset:0
ds_read_b64_tr_b16 v[90:91], v38 offset:256
ds_read_b64_tr_b16 v[92:93], v39 offset:0
ds_read_b64_tr_b16 v[94:95], v39 offset:256
ds_read_b64_tr_b16 v[96:97], v38 offset:2048
ds_read_b64_tr_b16 v[98:99], v38 offset:2304
ds_read_b64_tr_b16 v[100:101], v39 offset:2048
ds_read_b64_tr_b16 v[102:103], v39 offset:2304
ds_read_b64_tr_b16 v[104:105], v38 offset:4096
ds_read_b64_tr_b16 v[106:107], v38 offset:4352
ds_read_b64_tr_b16 v[108:109], v39 offset:4096
ds_read_b64_tr_b16 v[110:111], v39 offset:4352
v_cvt_pk_bf16_f32 v144, v72, v73
v_cvt_pk_bf16_f32 v145, v74, v75
v_cvt_pk_bf16_f32 v146, v84, v85
v_cvt_pk_bf16_f32 v147, v86, v87
v_cvt_pk_bf16_f32 v136, v64, v65
v_cvt_pk_bf16_f32 v137, v66, v67
v_cvt_pk_bf16_f32 v138, v68, v69
v_cvt_pk_bf16_f32 v139, v70, v71
v_cvt_pk_bf16_f32 v140, v76, v77
v_cvt_pk_bf16_f32 v141, v78, v79
v_cvt_pk_bf16_f32 v142, v80, v81
v_cvt_pk_bf16_f32 v143, v82, v83
v_permlane32_swap_b32 v144, v146
v_permlane32_swap_b32 v145, v147
s_add_u32 s70, s56, 49152
s_addc_u32 s71, s57, 0
global_store_dwordx4 v19, v[136:139], s[56:57] sc1
global_store_dwordx4 v19, v[140:143], s[70:71] sc1
global_store_dwordx4 v20, v[144:147], s[56:57] sc1
s_mov_b32 s54, s62
s_mov_b32 s55, s63
s_add_u32 s56, s56, 3145728
s_addc_u32 s57, s57, 0
s_mov_b32 s6, 0
L29_stage:
v_cmp_u_f32 vcc, v40, v42
s_cbranch_vccnz L30_redo
L31_go:
s_waitcnt lgkmcnt(8)
v_mfma_f32_16x16x32_bf16 v[64:67], a[0:3], v[88:91], 0
ds_read_b64_tr_b16 v[112:113], v38 offset:6144
global_load_dwordx4 a[244:247], v2, s[94:95] offset:2048 sc1
v_mfma_f32_16x16x32_bf16 v[68:71], a[4:7], v[88:91], 0
ds_read_b64_tr_b16 v[114:115], v38 offset:6400
v_mul_f32 v40, 0x3acccccd, v40
v_mfma_f32_16x16x32_bf16 v[72:75], a[8:11], v[88:91], 0
ds_read_b64_tr_b16 v[116:117], v39 offset:6144
v_mul_f32 v42, 0x3acccccd, v42
v_mfma_f32_16x16x32_bf16 v[76:79], a[0:3], v[92:95], 0
ds_read_b64_tr_b16 v[118:119], v39 offset:6400
v_mul_f32 v41, 0x3acccccd, v41
v_mfma_f32_16x16x32_bf16 v[80:83], a[4:7], v[92:95], 0
v_mul_f32 v43, 0x3acccccd, v43
v_fma_f32 v41, -v40, v40, v41
v_mfma_f32_16x16x32_bf16 v[84:87], a[8:11], v[92:95], 0
global_load_dwordx4 a[248:251], v2, s[94:95] offset:3072 sc1
s_waitcnt lgkmcnt(8)
v_mfma_f32_16x16x32_bf16 v[64:67], a[12:15], v[96:99], v[64:67]
ds_read_b64_tr_b16 v[88:89], v38 offset:8192
v_fma_f32 v43, -v42, v42, v43
v_mfma_f32_16x16x32_bf16 v[68:71], a[16:19], v[96:99], v[68:71]
ds_read_b64_tr_b16 v[90:91], v38 offset:8448
v_max_f32 v41, 0, v41
v_mfma_f32_16x16x32_bf16 v[72:75], a[20:23], v[96:99], v[72:75]
ds_read_b64_tr_b16 v[92:93], v39 offset:8192
v_max_f32 v43, 0, v43
v_mfma_f32_16x16x32_bf16 v[76:79], a[12:15], v[100:103], v[76:79]
ds_read_b64_tr_b16 v[94:95], v39 offset:8448
v_cvt_pk_bf16_f32 v4, v40, v40
v_mfma_f32_16x16x32_bf16 v[80:83], a[16:19], v[100:103], v[80:83]
global_load_dwordx4 a[252:255], v9, s[94:95] offset:-4096 sc1
v_cvt_pk_bf16_f32 v5, v42, v42
v_mfma_f32_16x16x32_bf16 v[84:87], a[20:23], v[100:103], v[84:87]
v_cvt_pk_bf16_f32 v41, v41, v41
s_waitcnt lgkmcnt(8)
v_mfma_f32_16x16x32_bf16 v[64:67], a[24:27], v[104:107], v[64:67]
ds_read_b64_tr_b16 v[96:97], v38 offset:10240
v_cvt_pk_bf16_f32 v43, v43, v43
v_mfma_f32_16x16x32_bf16 v[68:71], a[28:31], v[104:107], v[68:71]
ds_read_b64_tr_b16 v[98:99], v38 offset:10496
v_lshlrev_b32 v41, 16, v41
v_mfma_f32_16x16x32_bf16 v[72:75], a[32:35], v[104:107], v[72:75]
ds_read_b64_tr_b16 v[100:101], v39 offset:10240
v_lshlrev_b32 v43, 16, v43
v_mfma_f32_16x16x32_bf16 v[76:79], a[24:27], v[108:111], v[76:79]
ds_read_b64_tr_b16 v[102:103], v39 offset:10496
global_load_dwordx4 a[0:3], v9, s[94:95] offset:-3072 sc1
v_mfma_f32_16x16x32_bf16 v[80:83], a[28:31], v[108:111], v[80:83]
v_add_f32 v41, 0x3727c5ac, v41
v_add_f32 v43, 0x3727c5ac, v43
v_mfma_f32_16x16x32_bf16 v[84:87], a[32:35], v[108:111], v[84:87]
v_cvt_pk_bf16_f32 v41, v41, v41
s_waitcnt lgkmcnt(8)
v_mfma_f32_16x16x32_bf16 v[64:67], a[36:39], v[112:115], v[64:67]
ds_read_b64_tr_b16 v[104:105], v38 offset:12288
v_cvt_pk_bf16_f32 v43, v43, v43
v_mfma_f32_16x16x32_bf16 v[68:71], a[40:43], v[112:115], v[68:71]
ds_read_b64_tr_b16 v[106:107], v38 offset:12544
v_lshlrev_b32 v41, 16, v41
v_mfma_f32_16x16x32_bf16 v[72:75], a[44:47], v[112:115], v[72:75]
ds_read_b64_tr_b16 v[108:109], v39 offset:12288
global_load_dwordx4 a[4:7], v9, s[94:95] offset:-2048 sc1
v_mfma_f32_16x16x32_bf16 v[76:79], a[36:39], v[116:119], v[76:79]
ds_read_b64_tr_b16 v[110:111], v39 offset:12544
v_lshlrev_b32 v43, 16, v43
v_mfma_f32_16x16x32_bf16 v[80:83], a[40:43], v[116:119], v[80:83]
v_sqrt_f32 v41, v41
v_mfma_f32_16x16x32_bf16 v[84:87], a[44:47], v[116:119], v[84:87]
v_sqrt_f32 v43, v43
s_waitcnt lgkmcnt(8)
v_mfma_f32_16x16x32_bf16 v[64:67], a[48:51], v[88:91], v[64:67]
ds_read_b64_tr_b16 v[112:113], v38 offset:14336
v_mfma_f32_16x16x32_bf16 v[68:71], a[52:55], v[88:91], v[68:71]
ds_read_b64_tr_b16 v[114:115], v38 offset:14592
global_load_dwordx4 a[8:11], v9, s[94:95] offset:-1024 sc1
v_mfma_f32_16x16x32_bf16 v[72:75], a[56:59], v[88:91], v[72:75]
ds_read_b64_tr_b16 v[116:117], v39 offset:14336
v_cvt_pk_bf16_f32 v41, v41, v41
v_mfma_f32_16x16x32_bf16 v[76:79], a[48:51], v[92:95], v[76:79]
ds_read_b64_tr_b16 v[118:119], v39 offset:14592
v_cvt_pk_bf16_f32 v43, v43, v43
v_mfma_f32_16x16x32_bf16 v[80:83], a[52:55], v[92:95], v[80:83]
v_lshlrev_b32 v41, 16, v41
v_lshlrev_b32 v43, 16, v43
v_mfma_f32_16x16x32_bf16 v[84:87], a[56:59], v[92:95], v[84:87]
v_rcp_f32 v32, v41
s_waitcnt lgkmcnt(8)
v_mfma_f32_16x16x32_bf16 v[64:67], a[60:63], v[96:99], v[64:67]
ds_read_b64_tr_b16 v[88:89], v38 offset:16384
v_mfma_f32_16x16x32_bf16 v[68:71], a[64:67], v[96:99], v[68:71]
ds_read_b64_tr_b16 v[90:91], v38 offset:16640
global_load_dwordx4 a[12:15], v9, s[94:95] offset:0 sc1
v_mfma_f32_16x16x32_bf16 v[72:75], a[68:71], v[96:99], v[72:75]
ds_read_b64_tr_b16 v[92:93], v39 offset:16384
v_rcp_f32 v33, v43
v_mfma_f32_16x16x32_bf16 v[76:79], a[60:63], v[100:103], v[76:79]
ds_read_b64_tr_b16 v[94:95], v39 offset:16640
v_mfma_f32_16x16x32_bf16 v[80:83], a[64:67], v[100:103], v[80:83]
v_and_b32 v4, 0xffff0000, v4
v_and_b32 v5, 0xffff0000, v5
v_mfma_f32_16x16x32_bf16 v[84:87], a[68:71], v[100:103], v[84:87]
global_load_dwordx4 a[16:19], v9, s[94:95] offset:1024 sc1
s_waitcnt lgkmcnt(8)
v_mfma_f32_16x16x32_bf16 v[64:67], a[72:75], v[104:107], v[64:67]
ds_read_b64_tr_b16 v[96:97], v38 offset:18432
v_mul_f32 v34, -v4, v32
v_mfma_f32_16x16x32_bf16 v[68:71], a[76:79], v[104:107], v[68:71]
ds_read_b64_tr_b16 v[98:99], v38 offset:18688
v_mul_f32 v35, -v5, v33
v_mfma_f32_16x16x32_bf16 v[72:75], a[80:83], v[104:107], v[72:75]
ds_read_b64_tr_b16 v[100:101], v39 offset:18432
v_fma_f32 v136, v124, v34, v160
v_mfma_f32_16x16x32_bf16 v[76:79], a[72:75], v[108:111], v[76:79]
ds_read_b64_tr_b16 v[102:103], v39 offset:18688
v_fma_f32 v137, v125, v34, v161
v_mfma_f32_16x16x32_bf16 v[80:83], a[76:79], v[108:111], v[80:83]
global_load_dwordx4 a[20:23], v9, s[94:95] offset:2048 sc1
v_fma_f32 v138, v126, v34, v162
v_mfma_f32_16x16x32_bf16 v[84:87], a[80:83], v[108:111], v[84:87]
v_fma_f32 v139, v127, v34, v163
s_waitcnt lgkmcnt(8)
v_mfma_f32_16x16x32_bf16 v[64:67], a[84:87], v[112:115], v[64:67]
ds_read_b64_tr_b16 v[104:105], v38 offset:20480
v_fma_f32 v140, v128, v34, v164
v_mfma_f32_16x16x32_bf16 v[68:71], a[88:91], v[112:115], v[68:71]
ds_read_b64_tr_b16 v[106:107], v38 offset:20736
v_fma_f32 v141, v129, v34, v165
v_mfma_f32_16x16x32_bf16 v[72:75], a[92:95], v[112:115], v[72:75]
ds_read_b64_tr_b16 v[108:109], v39 offset:20480
v_fma_f32 v142, v130, v34, v166
v_mfma_f32_16x16x32_bf16 v[76:79], a[84:87], v[116:119], v[76:79]
ds_read_b64_tr_b16 v[110:111], v39 offset:20736
global_load_dwordx4 a[24:27], v2, s[96:97] offset:-4096 sc1
v_mfma_f32_16x16x32_bf16 v[80:83], a[88:91], v[116:119], v[80:83]
v_fma_f32 v143, v131, v34, v167
v_fma_f32 v144, v132, v34, v168
v_mfma_f32_16x16x32_bf16 v[84:87], a[92:95], v[116:119], v[84:87]
v_fma_f32 v145, v133, v34, v169
s_waitcnt lgkmcnt(8)
v_mfma_f32_16x16x32_bf16 v[64:67], a[96:99], v[88:91], v[64:67]
ds_read_b64_tr_b16 v[112:113], v38 offset:22528
v_fma_f32 v146, v134, v34, v170
v_mfma_f32_16x16x32_bf16 v[68:71], a[100:103], v[88:91], v[68:71]
ds_read_b64_tr_b16 v[114:115], v38 offset:22784
v_fma_f32 v147, v135, v34, v171
v_mfma_f32_16x16x32_bf16 v[72:75], a[104:107], v[88:91], v[72:75]
ds_read_b64_tr_b16 v[116:117], v39 offset:22528
global_load_dwordx4 a[28:31], v2, s[96:97] offset:-3072 sc1
v_mfma_f32_16x16x32_bf16 v[76:79], a[96:99], v[92:95], v[76:79]
ds_read_b64_tr_b16 v[118:119], v39 offset:22784
v_fma_f32 v148, v124, v35, v160
v_mfma_f32_16x16x32_bf16 v[80:83], a[100:103], v[92:95], v[80:83]
v_fma_f32 v149, v125, v35, v161
v_fma_f32 v150, v126, v35, v162
v_mfma_f32_16x16x32_bf16 v[84:87], a[104:107], v[92:95], v[84:87]
v_fma_f32 v151, v127, v35, v163
s_waitcnt lgkmcnt(8)
v_mfma_f32_16x16x32_bf16 v[64:67], a[108:111], v[96:99], v[64:67]
ds_read_b64_tr_b16 v[88:89], v38 offset:24576
v_fma_f32 v152, v128, v35, v164
v_mfma_f32_16x16x32_bf16 v[68:71], a[112:115], v[96:99], v[68:71]
ds_read_b64_tr_b16 v[90:91], v38 offset:24832
global_load_dwordx4 a[32:35], v2, s[96:97] offset:-2048 sc1
v_mfma_f32_16x16x32_bf16 v[72:75], a[116:119], v[96:99], v[72:75]
ds_read_b64_tr_b16 v[92:93], v39 offset:24576
v_fma_f32 v153, v129, v35, v165
v_mfma_f32_16x16x32_bf16 v[76:79], a[108:111], v[100:103], v[76:79]
ds_read_b64_tr_b16 v[94:95], v39 offset:24832
v_fma_f32 v154, v130, v35, v166
v_mfma_f32_16x16x32_bf16 v[80:83], a[112:115], v[100:103], v[80:83]
v_fma_f32 v155, v131, v35, v167
v_fma_f32 v156, v132, v35, v168
v_mfma_f32_16x16x32_bf16 v[84:87], a[116:119], v[100:103], v[84:87]
v_fma_f32 v157, v133, v35, v169
s_waitcnt lgkmcnt(8)
v_mfma_f32_16x16x32_bf16 v[64:67], a[120:123], v[104:107], v[64:67]
ds_read_b64_tr_b16 v[96:97], v38 offset:26624
global_load_dwordx4 a[36:39], v2, s[96:97] offset:-1024 sc1
v_mfma_f32_16x16x32_bf16 v[68:71], a[124:127], v[104:107], v[68:71]
ds_read_b64_tr_b16 v[98:99], v38 offset:26880
v_fma_f32 v158, v134, v35, v170
v_mfma_f32_16x16x32_bf16 v[72:75], a[128:131], v[104:107], v[72:75]
ds_read_b64_tr_b16 v[100:101], v39 offset:26624
v_fma_f32 v159, v135, v35, v171
v_mfma_f32_16x16x32_bf16 v[76:79], a[120:123], v[108:111], v[76:79]
ds_read_b64_tr_b16 v[102:103], v39 offset:26880
v_mfma_f32_16x16x32_bf16 v[80:83], a[124:127], v[108:111], v[80:83]
v_mfma_f32_16x16x32_bf16 v[84:87], a[128:131], v[108:111], v[84:87]
global_load_dwordx4 a[40:43], v2, s[8:9] offset:0 sc1
s_waitcnt lgkmcnt(8)
v_mfma_f32_16x16x32_bf16 v[64:67], a[132:135], v[112:115], v[64:67]
ds_read_b64_tr_b16 v[104:105], v38 offset:28672
v_mfma_f32_16x16x32_bf16 v[68:71], a[136:139], v[112:115], v[68:71]
ds_read_b64_tr_b16 v[106:107], v38 offset:28928
v_mfma_f32_16x16x32_bf16 v[72:75], a[140:143], v[112:115], v[72:75]
ds_read_b64_tr_b16 v[108:109], v39 offset:28672
v_mfma_f32_16x16x32_bf16 v[76:79], a[132:135], v[116:119], v[76:79]
ds_read_b64_tr_b16 v[110:111], v39 offset:28928
global_load_dwordx4 a[44:47], v7, s[8:9] offset:0 sc1
v_mfma_f32_16x16x32_bf16 v[80:83], a[136:139], v[116:119], v[80:83]
v_mfma_f32_16x16x32_bf16 v[84:87], a[140:143], v[116:119], v[84:87]
s_waitcnt lgkmcnt(8)
v_mfma_f32_16x16x32_bf16 v[64:67], a[144:147], v[88:91], v[64:67]
ds_read_b64_tr_b16 v[112:113], v38 offset:30720
v_mfma_f32_16x16x32_bf16 v[68:71], a[148:151], v[88:91], v[68:71]
ds_read_b64_tr_b16 v[114:115], v38 offset:30976
global_load_dwordx4 a[48:51], v2, s[8:9] offset:1024 sc1
v_mfma_f32_16x16x32_bf16 v[72:75], a[152:155], v[88:91], v[72:75]
ds_read_b64_tr_b16 v[116:117], v39 offset:30720
v_mfma_f32_16x16x32_bf16 v[76:79], a[144:147], v[92:95], v[76:79]
ds_read_b64_tr_b16 v[118:119], v39 offset:30976
v_mfma_f32_16x16x32_bf16 v[80:83], a[148:151], v[92:95], v[80:83]
v_mfma_f32_16x16x32_bf16 v[84:87], a[152:155], v[92:95], v[84:87]
global_load_dwordx4 a[52:55], v7, s[8:9] offset:1024 sc1
s_waitcnt lgkmcnt(8)
v_mfma_f32_16x16x32_bf16 v[64:67], a[156:159], v[96:99], v[64:67]
ds_read_b64_tr_b16 v[88:89], v38 offset:32768
v_mfma_f32_16x16x32_bf16 v[68:71], a[160:163], v[96:99], v[68:71]
ds_read_b64_tr_b16 v[90:91], v38 offset:33024
v_mfma_f32_16x16x32_bf16 v[72:75], a[164:167], v[96:99], v[72:75]
ds_read_b64_tr_b16 v[92:93], v39 offset:32768
v_mfma_f32_16x16x32_bf16 v[76:79], a[156:159], v[100:103], v[76:79]
ds_read_b64_tr_b16 v[94:95], v39 offset:33024
global_load_dwordx4 a[56:59], v2, s[8:9] offset:2048 sc1
v_mfma_f32_16x16x32_bf16 v[80:83], a[160:163], v[100:103], v[80:83]
v_mfma_f32_16x16x32_bf16 v[84:87], a[164:167], v[100:103], v[84:87]
s_waitcnt lgkmcnt(8)
v_mfma_f32_16x16x32_bf16 v[64:67], a[168:171], v[104:107], v[64:67]
ds_read_b64_tr_b16 v[96:97], v38 offset:34816
v_mfma_f32_16x16x32_bf16 v[68:71], a[172:175], v[104:107], v[68:71]
ds_read_b64_tr_b16 v[98:99], v38 offset:35072
global_load_dwordx4 a[60:63], v7, s[8:9] offset:2048 sc1
v_mfma_f32_16x16x32_bf16 v[72:75], a[176:179], v[104:107], v[72:75]
ds_read_b64_tr_b16 v[100:101], v39 offset:34816
v_mfma_f32_16x16x32_bf16 v[76:79], a[168:171], v[108:111], v[76:79]
ds_read_b64_tr_b16 v[102:103], v39 offset:35072
v_mfma_f32_16x16x32_bf16 v[80:83], a[172:175], v[108:111], v[80:83]
v_mfma_f32_16x16x32_bf16 v[84:87], a[176:179], v[108:111], v[84:87]
global_load_dwordx4 a[64:67], v2, s[8:9] offset:3072 sc1
s_waitcnt lgkmcnt(8)
v_mfma_f32_16x16x32_bf16 v[64:67], a[180:183], v[112:115], v[64:67]
ds_read_b64_tr_b16 v[104:105], v38 offset:36864
v_mfma_f32_16x16x32_bf16 v[68:71], a[184:187], v[112:115], v[68:71]
ds_read_b64_tr_b16 v[106:107], v38 offset:37120
v_mfma_f32_16x16x32_bf16 v[72:75], a[188:191], v[112:115], v[72:75]
ds_read_b64_tr_b16 v[108:109], v39 offset:36864
v_mfma_f32_16x16x32_bf16 v[76:79], a[180:183], v[116:119], v[76:79]
ds_read_b64_tr_b16 v[110:111], v39 offset:37120
global_load_dwordx4 a[68:71], v7, s[8:9] offset:3072 sc1
v_mfma_f32_16x16x32_bf16 v[80:83], a[184:187], v[116:119], v[80:83]
v_mfma_f32_16x16x32_bf16 v[84:87], a[188:191], v[116:119], v[84:87]
s_waitcnt lgkmcnt(8)
v_mfma_f32_16x16x32_bf16 v[64:67], a[192:195], v[88:91], v[64:67]
ds_read_b64_tr_b16 v[112:113], v38 offset:38912
v_mfma_f32_16x16x32_bf16 v[68:71], a[196:199], v[88:91], v[68:71]
ds_read_b64_tr_b16 v[114:115], v38 offset:39168
global_load_dwordx4 a[72:75], v2, s[10:11] offset:0 sc1
v_mfma_f32_16x16x32_bf16 v[72:75], a[200:203], v[88:91], v[72:75]
ds_read_b64_tr_b16 v[116:117], v39 offset:38912
v_mfma_f32_16x16x32_bf16 v[76:79], a[192:195], v[92:95], v[76:79]
ds_read_b64_tr_b16 v[118:119], v39 offset:39168
v_mfma_f32_16x16x32_bf16 v[80:83], a[196:199], v[92:95], v[80:83]
v_mfma_f32_16x16x32_bf16 v[84:87], a[200:203], v[92:95], v[84:87]
global_load_dwordx4 a[76:79], v7, s[10:11] offset:0 sc1
s_waitcnt lgkmcnt(8)
v_mfma_f32_16x16x32_bf16 v[64:67], a[204:207], v[96:99], v[64:67]
v_mfma_f32_16x16x32_bf16 v[68:71], a[208:211], v[96:99], v[68:71]
v_mfma_f32_16x16x32_bf16 v[72:75], a[212:215], v[96:99], v[72:75]
v_mfma_f32_16x16x32_bf16 v[76:79], a[204:207], v[100:103], v[76:79]
global_load_dwordx4 a[80:83], v2, s[10:11] offset:1024 sc1
v_mfma_f32_16x16x32_bf16 v[80:83], a[208:211], v[100:103], v[80:83]
v_mfma_f32_16x16x32_bf16 v[84:87], a[212:215], v[100:103], v[84:87]
s_waitcnt lgkmcnt(4)
v_mfma_f32_16x16x32_bf16 v[64:67], a[216:219], v[104:107], v[64:67]
v_mfma_f32_16x16x32_bf16 v[68:71], a[220:223], v[104:107], v[68:71]
global_load_dwordx4 a[84:87], v7, s[10:11] offset:1024 sc1
v_mfma_f32_16x16x32_bf16 v[72:75], a[224:227], v[104:107], v[72:75]
v_mfma_f32_16x16x32_bf16 v[76:79], a[216:219], v[108:111], v[76:79]
v_mfma_f32_16x16x32_bf16 v[80:83], a[220:223], v[108:111], v[80:83]
v_mfma_f32_16x16x32_bf16 v[84:87], a[224:227], v[108:111], v[84:87]
global_load_dwordx4 a[88:91], v2, s[96:97] offset:0 sc1
s_waitcnt lgkmcnt(0)
v_mfma_f32_16x16x32_bf16 v[64:67], a[228:231], v[112:115], v[64:67]
v_mfma_f32_16x16x32_bf16 v[68:71], a[232:235], v[112:115], v[68:71]
v_mfma_f32_16x16x32_bf16 v[72:75], a[236:239], v[112:115], v[72:75]
v_mfma_f32_16x16x32_bf16 v[76:79], a[228:231], v[116:119], v[76:79]
v_mfma_f32_16x16x32_bf16 v[80:83], a[232:235], v[116:119], v[80:83]
global_load_dwordx4 a[92:95], v2, s[10:11] offset:2048 sc1
v_mfma_f32_16x16x32_bf16 v[84:87], a[236:239], v[116:119], v[84:87]
s_nop 1
v_pk_fma_f32 v[64:65], v[64:65], v[32:33], v[136:137] op_sel:[0,0,0] op_sel_hi:[1,0,1]
v_pk_fma_f32 v[66:67], v[66:67], v[32:33], v[138:139] op_sel:[0,0,0] op_sel_hi:[1,0,1]
v_pk_fma_f32 v[68:69], v[68:69], v[32:33], v[140:141] op_sel:[0,0,0] op_sel_hi:[1,0,1]
v_pk_fma_f32 v[70:71], v[70:71], v[32:33], v[142:143] op_sel:[0,0,0] op_sel_hi:[1,0,1]
v_pk_fma_f32 v[72:73], v[72:73], v[32:33], v[144:145] op_sel:[0,0,0] op_sel_hi:[1,0,1]
v_pk_fma_f32 v[74:75], v[74:75], v[32:33], v[146:147] op_sel:[0,0,0] op_sel_hi:[1,0,1]
v_pk_fma_f32 v[76:77], v[76:77], v[32:33], v[148:149] op_sel:[0,1,0] op_sel_hi:[1,1,1]
v_pk_fma_f32 v[78:79], v[78:79], v[32:33], v[150:151] op_sel:[0,1,0] op_sel_hi:[1,1,1]
v_pk_fma_f32 v[80:81], v[80:81], v[32:33], v[152:153] op_sel:[0,1,0] op_sel_hi:[1,1,1]
v_pk_fma_f32 v[82:83], v[82:83], v[32:33], v[154:155] op_sel:[0,1,0] op_sel_hi:[1,1,1]
v_pk_fma_f32 v[84:85], v[84:85], v[32:33], v[156:157] op_sel:[0,1,0] op_sel_hi:[1,1,1]
v_pk_fma_f32 v[86:87], v[86:87], v[32:33], v[158:159] op_sel:[0,1,0] op_sel_hi:[1,1,1]
v_pk_mul_f32 v[88:89], v[64:65], v[64:65]
v_pk_mul_f32 v[90:91], v[66:67], v[66:67]
v_pk_mul_f32 v[92:93], v[68:69], v[68:69]
v_pk_mul_f32 v[94:95], v[70:71], v[70:71]
v_pk_mul_f32 v[96:97], v[72:73], v[72:73]
v_pk_mul_f32 v[98:99], v[74:75], v[74:75]
v_pk_mul_f32 v[100:101], v[76:77], v[76:77]
v_pk_mul_f32 v[102:103], v[78:79], v[78:79]
v_pk_mul_f32 v[104:105], v[80:81], v[80:81]
v_pk_mul_f32 v[106:107], v[82:83], v[82:83]
v_pk_mul_f32 v[108:109], v[84:85], v[84:85]
v_pk_mul_f32 v[110:111], v[86:87], v[86:87]
v_pk_fma_f32 v[88:89], v[88:89], s[26:27], v[62:63]
v_pk_fma_f32 v[90:91], v[90:91], s[26:27], v[62:63]
v_pk_fma_f32 v[92:93], v[92:93], s[26:27], v[62:63]
v_pk_fma_f32 v[94:95], v[94:95], s[26:27], v[62:63]
v_pk_fma_f32 v[96:97], v[96:97], s[26:27], v[62:63]
v_pk_fma_f32 v[98:99], v[98:99], s[26:27], v[62:63]
v_pk_fma_f32 v[100:101], v[100:101], s[26:27], v[62:63]
v_pk_fma_f32 v[102:103], v[102:103], s[26:27], v[62:63]
v_pk_fma_f32 v[104:105], v[104:105], s[26:27], v[62:63]
v_pk_fma_f32 v[106:107], v[106:107], s[26:27], v[62:63]
v_pk_fma_f32 v[108:109], v[108:109], s[26:27], v[62:63]
v_pk_fma_f32 v[110:111], v[110:111], s[26:27], v[62:63]
global_load_dwordx4 a[96:99], v7, s[10:11] offset:2048 sc1
global_load_dwordx4 a[100:103], v2, s[96:97] offset:1024 sc1
v_pk_mul_f32 v[88:89], v[88:89], v[64:65]
v_pk_mul_f32 v[90:91], v[90:91], v[66:67]
v_pk_mul_f32 v[92:93], v[92:93], v[68:69]
v_pk_mul_f32 v[94:95], v[94:95], v[70:71]
v_pk_mul_f32 v[96:97], v[96:97], v[72:73]
v_pk_mul_f32 v[98:99], v[98:99], v[74:75]
v_pk_mul_f32 v[100:101], v[100:101], v[76:77]
v_pk_mul_f32 v[102:103], v[102:103], v[78:79]
v_pk_mul_f32 v[104:105], v[104:105], v[80:81]
v_pk_mul_f32 v[106:107], v[106:107], v[82:83]
v_pk_mul_f32 v[108:109], v[108:109], v[84:85]
v_pk_mul_f32 v[110:111], v[110:111], v[86:87]
v_exp_f32 v88, v88
v_exp_f32 v89, v89
v_exp_f32 v90, v90
v_exp_f32 v91, v91
v_exp_f32 v92, v92
v_exp_f32 v93, v93
v_exp_f32 v94, v94
v_exp_f32 v95, v95
v_exp_f32 v96, v96
v_exp_f32 v97, v97
v_exp_f32 v98, v98
v_exp_f32 v99, v99
global_load_dwordx4 a[104:107], v2, s[96:97] offset:2048 sc1
global_load_dwordx4 a[108:111], v2, s[96:97] offset:3072 sc1
v_exp_f32 v100, v100
v_exp_f32 v101, v101
v_exp_f32 v102, v102
v_exp_f32 v103, v103
v_exp_f32 v104, v104
v_exp_f32 v105, v105
v_exp_f32 v106, v106
v_exp_f32 v107, v107
v_exp_f32 v108, v108
v_exp_f32 v109, v109
v_exp_f32 v110, v110
v_exp_f32 v111, v111
v_pk_add_f32 v[88:89], v[88:89], 1.0 op_sel_hi:[1,0]
v_pk_add_f32 v[90:91], v[90:91], 1.0 op_sel_hi:[1,0]
v_pk_add_f32 v[92:93], v[92:93], 1.0 op_sel_hi:[1,0]
v_pk_add_f32 v[94:95], v[94:95], 1.0 op_sel_hi:[1,0]
v_pk_add_f32 v[96:97], v[96:97], 1.0 op_sel_hi:[1,0]
v_pk_add_f32 v[98:99], v[98:99], 1.0 op_sel_hi:[1,0]
v_pk_add_f32 v[100:101], v[100:101], 1.0 op_sel_hi:[1,0]
v_pk_add_f32 v[102:103], v[102:103], 1.0 op_sel_hi:[1,0]
v_pk_add_f32 v[104:105], v[104:105], 1.0 op_sel_hi:[1,0]
v_pk_add_f32 v[106:107], v[106:107], 1.0 op_sel_hi:[1,0]
v_pk_add_f32 v[108:109], v[108:109], 1.0 op_sel_hi:[1,0]
v_pk_add_f32 v[110:111], v[110:111], 1.0 op_sel_hi:[1,0]
global_load_dwordx4 a[112:115], v9, s[96:97] offset:-4096 sc1
global_load_dwordx4 a[116:119], v9, s[96:97] offset:-3072 sc1
v_rcp_f32 v88, v88
v_rcp_f32 v89, v89
v_rcp_f32 v90, v90
v_rcp_f32 v91, v91
v_rcp_f32 v92, v92
v_rcp_f32 v93, v93
v_rcp_f32 v94, v94
v_rcp_f32 v95, v95
v_rcp_f32 v96, v96
v_rcp_f32 v97, v97
v_rcp_f32 v98, v98
v_rcp_f32 v99, v99
v_rcp_f32 v100, v100
v_rcp_f32 v101, v101
v_rcp_f32 v102, v102
v_rcp_f32 v103, v103
v_rcp_f32 v104, v104
v_rcp_f32 v105, v105
global_load_dwordx4 a[120:123], v2, s[10:11] offset:3072 sc1
global_load_dwordx4 a[124:127], v7, s[10:11] offset:3072 sc1
v_rcp_f32 v106, v106
v_rcp_f32 v107, v107
v_rcp_f32 v108, v108
v_rcp_f32 v109, v109
v_rcp_f32 v110, v110
v_rcp_f32 v111, v111
v_pk_mul_f32 v[64:65], v[64:65], v[88:89]
v_pk_mul_f32 v[66:67], v[66:67], v[90:91]
v_pk_mul_f32 v[68:69], v[68:69], v[92:93]
v_pk_mul_f32 v[70:71], v[70:71], v[94:95]
v_pk_mul_f32 v[72:73], v[72:73], v[96:97]
v_pk_mul_f32 v[74:75], v[74:75], v[98:99]
v_pk_mul_f32 v[76:77], v[76:77], v[100:101]
v_pk_mul_f32 v[78:79], v[78:79], v[102:103]
v_pk_mul_f32 v[80:81], v[80:81], v[104:105]
v_pk_mul_f32 v[82:83], v[82:83], v[106:107]
v_pk_mul_f32 v[84:85], v[84:85], v[108:109]
v_pk_mul_f32 v[86:87], v[86:87], v[110:111]
v_cvt_pk_bf16_f32 v144, v72, v73
v_cvt_pk_bf16_f32 v145, v74, v75
v_cvt_pk_bf16_f32 v146, v84, v85
v_cvt_pk_bf16_f32 v147, v86, v87
v_cvt_pk_bf16_f32 v136, v64, v65
v_cvt_pk_bf16_f32 v137, v66, v67
v_cvt_pk_bf16_f32 v138, v68, v69
v_cvt_pk_bf16_f32 v139, v70, v71
v_cvt_pk_bf16_f32 v140, v76, v77
v_cvt_pk_bf16_f32 v141, v78, v79
v_cvt_pk_bf16_f32 v142, v80, v81
v_cvt_pk_bf16_f32 v143, v82, v83
v_permlane32_swap_b32 v144, v146
v_permlane32_swap_b32 v145, v147
s_add_u32 s70, s56, 49152
s_addc_u32 s71, s57, 0
global_store_dwordx4 v19, v[136:139], s[56:57] sc1
global_store_dwordx4 v19, v[140:143], s[70:71] sc1
global_store_dwordx4 v20, v[144:147], s[56:57] sc1
s_waitcnt vmcnt(35)
s_waitcnt vmcnt(23)
v_mfma_f32_16x16x32_bf16 v[64:67], v[172:175], a[40:43], 0
global_load_dwordx4 a[128:131], v9, s[96:97] offset:-2048 sc1
v_mfma_f32_16x16x32_bf16 v[84:87], v[172:175], a[44:47], 0
v_mfma_f32_16x16x32_bf16 v[68:71], v[176:179], a[40:43], 0
v_lshlrev_b32 v36, 16, v54
v_and_b32 v37, 0xffff0000, v54
v_mfma_f32_16x16x32_bf16 v[88:91], v[176:179], a[44:47], 0
v_lshlrev_b32 v38, 16, v55
v_and_b32 v39, 0xffff0000, v55
v_mfma_f32_16x16x32_bf16 v[72:75], v[180:183], a[40:43], 0
global_load_dwordx4 a[132:135], v9, s[96:97] offset:-1024 sc1
v_lshlrev_b32 v40, 16, v56
v_mfma_f32_16x16x32_bf16 v[92:95], v[180:183], a[44:47], 0
v_and_b32 v41, 0xffff0000, v56
v_lshlrev_b32 v42, 16, v57
v_mfma_f32_16x16x32_bf16 v[76:79], v[184:187], a[40:43], 0
v_and_b32 v43, 0xffff0000, v57
v_lshlrev_b32 v44, 16, v58
v_mfma_f32_16x16x32_bf16 v[96:99], v[184:187], a[44:47], 0
v_and_b32 v45, 0xffff0000, v58
v_lshlrev_b32 v46, 16, v59
v_mfma_f32_16x16x32_bf16 v[80:83], v[188:191], a[40:43], 0
global_load_dwordx4 a[136:139], v9, s[96:97] offset:0 sc1
v_and_b32 v47, 0xffff0000, v59
v_mfma_f32_16x16x32_bf16 v[100:103], v[188:191], a[44:47], 0
v_add_u32 v4, 0, v25
s_waitcnt vmcnt(24)
v_mfma_f32_16x16x32_bf16 v[64:67], v[192:195], a[48:51], v[64:67]
v_add_u32 v5, 0, v26
ds_read_b64_tr_b16 v[144:145], v4
v_mfma_f32_16x16x32_bf16 v[84:87], v[192:195], a[52:55], v[84:87]
ds_read_b64_tr_b16 v[146:147], v4 offset:256
ds_read_b64_tr_b16 v[148:149], v5
v_mfma_f32_16x16x32_bf16 v[68:71], v[196:199], a[48:51], v[68:71]
global_load_dwordx4 a[140:143], v9, s[96:97] offset:1024 sc1
v_mfma_f32_16x16x32_bf16 v[88:91], v[196:199], a[52:55], v[88:91]
v_mfma_f32_16x16x32_bf16 v[72:75], v[200:203], a[48:51], v[72:75]
v_mfma_f32_16x16x32_bf16 v[92:95], v[200:203], a[52:55], v[92:95]
v_mfma_f32_16x16x32_bf16 v[76:79], v[204:207], a[48:51], v[76:79]
global_load_dwordx4 a[144:147], v9, s[96:97] offset:2048 sc1
v_mfma_f32_16x16x32_bf16 v[96:99], v[204:207], a[52:55], v[96:99]
v_mfma_f32_16x16x32_bf16 v[80:83], v[208:211], a[48:51], v[80:83]
v_mfma_f32_16x16x32_bf16 v[100:103], v[208:211], a[52:55], v[100:103]
s_waitcnt vmcnt(24)
v_mfma_f32_16x16x32_bf16 v[64:67], v[212:215], a[56:59], v[64:67]
global_load_dwordx4 a[148:151], v2, s[12:13] offset:0 sc1
s_waitcnt lgkmcnt(0)
v_mfma_f32_16x16x32_bf16 v[84:87], v[212:215], a[60:63], v[84:87]
v_lshlrev_b32 v150, 16, v144
v_and_b32 v151, 0xffff0000, v144
v_mfma_f32_16x16x32_bf16 v[68:71], v[216:219], a[56:59], v[68:71]
v_lshlrev_b32 v152, 16, v145
v_and_b32 v153, 0xffff0000, v145
v_mfma_f32_16x16x32_bf16 v[88:91], v[216:219], a[60:63], v[88:91]
v_lshlrev_b32 v154, 16, v146
v_and_b32 v155, 0xffff0000, v146
v_mfma_f32_16x16x32_bf16 v[72:75], v[220:223], a[56:59], v[72:75]
global_load_dwordx4 a[152:155], v7, s[12:13] offset:0 sc1
v_lshlrev_b32 v156, 16, v147
v_mfma_f32_16x16x32_bf16 v[92:95], v[220:223], a[60:63], v[92:95]
v_and_b32 v157, 0xffff0000, v147
v_lshlrev_b32 v158, 16, v148
v_mfma_f32_16x16x32_bf16 v[76:79], v[224:227], a[56:59], v[76:79]
v_and_b32 v159, 0xffff0000, v148
v_lshlrev_b32 v160, 16, v149
v_mfma_f32_16x16x32_bf16 v[96:99], v[224:227], a[60:63], v[96:99]
v_and_b32 v161, 0xffff0000, v149
v_add_f32 v150, v150, v36
v_mfma_f32_16x16x32_bf16 v[80:83], v[228:231], a[56:59], v[80:83]
global_load_dwordx4 a[156:159], v2, s[98:99] offset:-4096 sc1
v_add_f32 v151, v151, v37
v_mfma_f32_16x16x32_bf16 v[100:103], v[228:231], a[60:63], v[100:103]
v_add_f32 v152, v152, v38
s_waitcnt vmcnt(25)
v_mfma_f32_16x16x32_bf16 v[64:67], v[232:235], a[64:67], v[64:67]
v_add_f32 v153, v153, v39
v_add_f32 v154, v154, v40
v_mfma_f32_16x16x32_bf16 v[84:87], v[232:235], a[68:71], v[84:87]
v_add_f32 v155, v155, v41
v_add_f32 v156, v156, v42
v_mfma_f32_16x16x32_bf16 v[68:71], v[236:239], a[64:67], v[68:71]
global_load_dwordx4 a[160:163], v2, s[98:99] offset:-3072 sc1
v_add_f32 v157, v157, v43
v_mfma_f32_16x16x32_bf16 v[88:91], v[236:239], a[68:71], v[88:91]
v_add_f32 v158, v158, v44
v_add_f32 v159, v159, v45
v_mfma_f32_16x16x32_bf16 v[72:75], v[240:243], a[64:67], v[72:75]
v_add_f32 v160, v160, v46
v_add_f32 v161, v161, v47
v_mfma_f32_16x16x32_bf16 v[92:95], v[240:243], a[68:71], v[92:95]
v_add_u32 v4, 47904, v25
v_add_u32 v5, 47904, v26
v_mfma_f32_16x16x32_bf16 v[76:79], v[244:247], a[64:67], v[76:79]
global_load_dwordx4 a[164:167], v2, s[98:99] offset:-2048 sc1
ds_read_b64_tr_b16 v[144:145], v4
v_mfma_f32_16x16x32_bf16 v[96:99], v[244:247], a[68:71], v[96:99]
ds_read_b64_tr_b16 v[146:147], v4 offset:256
ds_read_b64_tr_b16 v[148:149], v5
v_mfma_f32_16x16x32_bf16 v[80:83], v[248:251], a[64:67], v[80:83]
v_mfma_f32_16x16x32_bf16 v[100:103], v[248:251], a[68:71], v[100:103]
s_waitcnt vmcnt(25)
s_waitcnt vmcnt(44)
v_mfma_f32_16x16x32_bf16 v[64:67], a[240:243], a[72:75], v[64:67]
global_load_dwordx4 a[168:171], v2, s[98:99] offset:-1024 sc1
v_mfma_f32_16x16x32_bf16 v[84:87], a[240:243], a[76:79], v[84:87]
v_mfma_f32_16x16x32_bf16 v[68:71], a[244:247], a[72:75], v[68:71]
v_mfma_f32_16x16x32_bf16 v[88:91], a[244:247], a[76:79], v[88:91]
v_mfma_f32_16x16x32_bf16 v[72:75], a[248:251], a[72:75], v[72:75]
global_load_dwordx4 a[172:175], v2, s[98:99] offset:0 sc1
v_mfma_f32_16x16x32_bf16 v[92:95], a[248:251], a[76:79], v[92:95]
v_mfma_f32_16x16x32_bf16 v[76:79], a[252:255], a[72:75], v[76:79]
v_mfma_f32_16x16x32_bf16 v[96:99], a[252:255], a[76:79], v[96:99]
v_mfma_f32_16x16x32_bf16 v[80:83], a[0:3], a[72:75], v[80:83]
global_load_dwordx4 a[176:179], v2, s[12:13] offset:1024 sc1
v_mfma_f32_16x16x32_bf16 v[100:103], a[0:3], a[76:79], v[100:103]
s_waitcnt vmcnt(26)
s_waitcnt vmcnt(42)
v_mfma_f32_16x16x32_bf16 v[64:67], a[4:7], a[80:83], v[64:67]
global_load_dwordx4 a[180:183], v7, s[12:13] offset:1024 sc1
s_waitcnt lgkmcnt(0)
v_mfma_f32_16x16x32_bf16 v[84:87], a[4:7], a[84:87], v[84:87]
v_lshlrev_b32 v4, 16, v144
v_and_b32 v5, 0xffff0000, v144
v_mfma_f32_16x16x32_bf16 v[68:71], a[8:11], a[80:83], v[68:71]
v_add_f32 v36, v36, v4
v_add_f32 v37, v37, v5
v_mfma_f32_16x16x32_bf16 v[88:91], a[8:11], a[84:87], v[88:91]
v_lshlrev_b32 v4, 16, v145
v_and_b32 v5, 0xffff0000, v145
v_mfma_f32_16x16x32_bf16 v[72:75], a[12:15], a[80:83], v[72:75]
global_load_dwordx4 a[184:187], v2, s[98:99] offset:1024 sc1
v_add_f32 v38, v38, v4
v_mfma_f32_16x16x32_bf16 v[92:95], a[12:15], a[84:87], v[92:95]
v_add_f32 v39, v39, v5
v_lshlrev_b32 v4, 16, v146
v_mfma_f32_16x16x32_bf16 v[76:79], a[16:19], a[80:83], v[76:79]
v_and_b32 v5, 0xffff0000, v146
v_add_f32 v40, v40, v4
v_mfma_f32_16x16x32_bf16 v[96:99], a[16:19], a[84:87], v[96:99]
v_add_f32 v41, v41, v5
v_lshlrev_b32 v4, 16, v147
v_mfma_f32_16x16x32_bf16 v[80:83], a[20:23], a[80:83], v[80:83]
global_load_dwordx4 a[188:191], v2, s[98:99] offset:2048 sc1
v_and_b32 v5, 0xffff0000, v147
v_mfma_f32_16x16x32_bf16 v[100:103], a[20:23], a[84:87], v[100:103]
s_waitcnt vmcnt(26)
s_waitcnt vmcnt(28)
v_mfma_f32_16x16x32_bf16 v[64:67], a[24:27], a[92:95], v[64:67]
global_load_dwordx4 a[192:195], v2, s[98:99] offset:3072 sc1
global_load_dwordx4 a[196:199], v9, s[98:99] offset:-4096 sc1
v_mfma_f32_16x16x32_bf16 v[84:87], a[24:27], a[96:99], v[84:87]
global_load_dwordx4 a[200:203], v9, s[98:99] offset:-3072 sc1
global_load_dwordx4 a[204:207], v2, s[12:13] offset:2048 sc1
v_mfma_f32_16x16x32_bf16 v[68:71], a[28:31], a[92:95], v[68:71]
global_load_dwordx4 a[208:211], v7, s[12:13] offset:2048 sc1
v_add_f32 v42, v42, v4
v_mfma_f32_16x16x32_bf16 v[88:91], a[28:31], a[96:99], v[88:91]
v_add_f32 v43, v43, v5
v_lshlrev_b32 v4, 16, v148
v_mfma_f32_16x16x32_bf16 v[72:75], a[32:35], a[92:95], v[72:75]
global_load_dwordx4 a[212:215], v9, s[98:99] offset:-2048 sc1
v_and_b32 v5, 0xffff0000, v148
v_mfma_f32_16x16x32_bf16 v[92:95], a[32:35], a[96:99], v[92:95]
v_add_f32 v44, v44, v4
v_add_f32 v45, v45, v5
v_mfma_f32_16x16x32_bf16 v[76:79], a[36:39], a[92:95], v[76:79]
v_lshlrev_b32 v4, 16, v149
v_and_b32 v5, 0xffff0000, v149
v_mfma_f32_16x16x32_bf16 v[96:99], a[36:39], a[96:99], v[96:99]
v_add_f32 v46, v46, v4
v_add_f32 v47, v47, v5
v_mfma_f32_16x16x32_bf16 v[80:83], a[88:91], a[92:95], v[80:83]
global_load_dwordx4 a[216:219], v9, s[98:99] offset:-1024 sc1
v_mfma_f32_16x16x32_bf16 v[100:103], a[88:91], a[96:99], v[100:103]
s_waitcnt vmcnt(26)
s_waitcnt vmcnt(28)
v_mfma_f32_16x16x32_bf16 v[64:67], a[100:103], a[120:123], v[64:67]
global_load_dwordx4 a[220:223], v9, s[98:99] offset:0 sc1
global_load_dwordx4 a[224:227], v9, s[98:99] offset:1024 sc1
v_mfma_f32_16x16x32_bf16 v[84:87], a[100:103], a[124:127], v[84:87]
global_load_dwordx4 a[228:231], v9, s[98:99] offset:2048 sc1
global_load_dwordx4 a[232:235], v2, s[12:13] offset:3072 sc1
v_mfma_f32_16x16x32_bf16 v[68:71], a[104:107], a[120:123], v[68:71]
global_load_dwordx4 a[236:239], v7, s[12:13] offset:3072 sc1
v_mfma_f32_16x16x32_bf16 v[88:91], a[104:107], a[124:127], v[88:91]
v_mfma_f32_16x16x32_bf16 v[72:75], a[108:111], a[120:123], v[72:75]
global_load_dwordx4 a[40:43], v2, s[48:49] offset:0 sc1
v_mfma_f32_16x16x32_bf16 v[92:95], a[108:111], a[124:127], v[92:95]
v_mfma_f32_16x16x32_bf16 v[76:79], a[112:115], a[120:123], v[76:79]
v_mfma_f32_16x16x32_bf16 v[96:99], a[112:115], a[124:127], v[96:99]
v_mfma_f32_16x16x32_bf16 v[80:83], a[116:119], a[120:123], v[80:83]
global_load_dwordx4 a[44:47], v7, s[48:49] offset:0 sc1
v_mfma_f32_16x16x32_bf16 v[100:103], a[116:119], a[124:127], v[100:103]
s_waitcnt vmcnt(23)
s_waitcnt vmcnt(25)
v_mfma_f32_16x16x32_bf16 v[64:67], a[128:131], a[148:151], v[64:67]
v_mfma_f32_16x16x32_bf16 v[84:87], a[128:131], a[152:155], v[84:87]
v_mfma_f32_16x16x32_bf16 v[68:71], a[132:135], a[148:151], v[68:71]
global_load_dwordx4 a[48:51], v2, s[48:49] offset:1024 sc1
v_mfma_f32_16x16x32_bf16 v[88:91], a[132:135], a[152:155], v[88:91]
v_mfma_f32_16x16x32_bf16 v[72:75], a[136:139], a[148:151], v[72:75]
v_mfma_f32_16x16x32_bf16 v[92:95], a[136:139], a[152:155], v[92:95]
v_mfma_f32_16x16x32_bf16 v[76:79], a[140:143], a[148:151], v[76:79]
global_load_dwordx4 a[52:55], v7, s[48:49] offset:1024 sc1
v_mfma_f32_16x16x32_bf16 v[96:99], a[140:143], a[152:155], v[96:99]
v_mfma_f32_16x16x32_bf16 v[80:83], a[144:147], a[148:151], v[80:83]
v_mfma_f32_16x16x32_bf16 v[100:103], a[144:147], a[152:155], v[100:103]
s_waitcnt vmcnt(18)
s_waitcnt vmcnt(20)
v_mfma_f32_16x16x32_bf16 v[64:67], a[156:159], a[176:179], v[64:67]
global_load_dwordx4 a[56:59], v2, s[48:49] offset:2048 sc1
v_mfma_f32_16x16x32_bf16 v[84:87], a[156:159], a[180:183], v[84:87]
v_mfma_f32_16x16x32_bf16 v[68:71], a[160:163], a[176:179], v[68:71]
v_mfma_f32_16x16x32_bf16 v[88:91], a[160:163], a[180:183], v[88:91]
v_mfma_f32_16x16x32_bf16 v[72:75], a[164:167], a[176:179], v[72:75]
global_load_dwordx4 a[60:63], v7, s[48:49] offset:2048 sc1
v_mfma_f32_16x16x32_bf16 v[92:95], a[164:167], a[180:183], v[92:95]
v_mfma_f32_16x16x32_bf16 v[76:79], a[168:171], a[176:179], v[76:79]
v_mfma_f32_16x16x32_bf16 v[96:99], a[168:171], a[180:183], v[96:99]
v_mfma_f32_16x16x32_bf16 v[80:83], a[172:175], a[176:179], v[80:83]
global_load_dwordx4 a[64:67], v2, s[48:49] offset:3072 sc1
v_mfma_f32_16x16x32_bf16 v[100:103], a[172:175], a[180:183], v[100:103]
s_waitcnt vmcnt(14)
s_waitcnt vmcnt(16)
v_mfma_f32_16x16x32_bf16 v[64:67], a[184:187], a[204:207], v[64:67]
v_mfma_f32_16x16x32_bf16 v[84:87], a[184:187], a[208:211], v[84:87]
v_mfma_f32_16x16x32_bf16 v[68:71], a[188:191], a[204:207], v[68:71]
global_load_dwordx4 a[68:71], v7, s[48:49] offset:3072 sc1
v_mfma_f32_16x16x32_bf16 v[88:91], a[188:191], a[208:211], v[88:91]
v_mfma_f32_16x16x32_bf16 v[72:75], a[192:195], a[204:207], v[72:75]
v_mfma_f32_16x16x32_bf16 v[92:95], a[192:195], a[208:211], v[92:95]
v_mfma_f32_16x16x32_bf16 v[76:79], a[196:199], a[204:207], v[76:79]
global_load_dwordx4 a[72:75], v2, s[50:51] offset:0 sc1
v_mfma_f32_16x16x32_bf16 v[96:99], a[196:199], a[208:211], v[96:99]
v_mfma_f32_16x16x32_bf16 v[80:83], a[200:203], a[204:207], v[80:83]
v_mfma_f32_16x16x32_bf16 v[100:103], a[200:203], a[208:211], v[100:103]
s_waitcnt vmcnt(9)
s_waitcnt vmcnt(11)
v_mfma_f32_16x16x32_bf16 v[64:67], a[212:215], a[232:235], v[64:67]
global_load_dwordx4 a[76:79], v7, s[50:51] offset:0 sc1
v_mfma_f32_16x16x32_bf16 v[84:87], a[212:215], a[236:239], v[84:87]
v_mfma_f32_16x16x32_bf16 v[68:71], a[216:219], a[232:235], v[68:71]
v_mfma_f32_16x16x32_bf16 v[88:91], a[216:219], a[236:239], v[88:91]
v_mfma_f32_16x16x32_bf16 v[72:75], a[220:223], a[232:235], v[72:75]
global_load_dwordx4 a[80:83], v2, s[50:51] offset:1024 sc1
v_mfma_f32_16x16x32_bf16 v[92:95], a[220:223], a[236:239], v[92:95]
v_mfma_f32_16x16x32_bf16 v[76:79], a[224:227], a[232:235], v[76:79]
v_mfma_f32_16x16x32_bf16 v[96:99], a[224:227], a[236:239], v[96:99]
v_mfma_f32_16x16x32_bf16 v[80:83], a[228:231], a[232:235], v[80:83]
global_load_dwordx4 a[84:87], v7, s[50:51] offset:1024 sc1
v_mfma_f32_16x16x32_bf16 v[100:103], a[228:231], a[236:239], v[100:103]
s_mov_b32 s6, 0
L33_g2c:
v_cmp_u_f32 vcc, v64, v84
s_cbranch_vccnz L32_g2r
L34_g2g:
s_waitcnt vmcnt(10)
v_mfma_f32_16x16x32_bf16 v[104:107], v[172:175], a[40:43], 0
global_load_dwordx4 a[92:95], v2, s[50:51] offset:2048 sc1
v_mfma_f32_16x16x32_bf16 v[124:127], v[172:175], a[44:47], 0
ds_write_b128 v22, v[64:67] offset:0
v_mfma_f32_16x16x32_bf16 v[108:111], v[176:179], a[40:43], 0
ds_write_b128 v22, v[68:71] offset:1024
v_mfma_f32_16x16x32_bf16 v[128:131], v[176:179], a[44:47], 0
v_mfma_f32_16x16x32_bf16 v[112:115], v[180:183], a[40:43], 0
global_load_dwordx4 a[96:99], v7, s[50:51] offset:2048 sc1
ds_write_b128 v22, v[72:75] offset:2048
v_mfma_f32_16x16x32_bf16 v[132:135], v[180:183], a[44:47], 0
v_mfma_f32_16x16x32_bf16 v[116:119], v[184:187], a[40:43], 0
ds_write_b128 v22, v[76:79] offset:3072
v_mfma_f32_16x16x32_bf16 v[136:139], v[184:187], a[44:47], 0
ds_write_b128 v22, v[80:83] offset:4096
v_mfma_f32_16x16x32_bf16 v[120:123], v[188:191], a[40:43], 0
v_mfma_f32_16x16x32_bf16 v[140:143], v[188:191], a[44:47], 0
global_load_dwordx4 a[120:123], v2, s[50:51] offset:3072 sc1
s_waitcnt vmcnt(11)
v_mfma_f32_16x16x32_bf16 v[104:107], v[192:195], a[48:51], v[104:107]
ds_write_b128 v22, v[84:87] offset:5120
v_mfma_f32_16x16x32_bf16 v[124:127], v[192:195], a[52:55], v[124:127]
ds_write_b128 v22, v[88:91] offset:6144
v_mfma_f32_16x16x32_bf16 v[108:111], v[196:199], a[48:51], v[108:111]
v_mfma_f32_16x16x32_bf16 v[128:131], v[196:199], a[52:55], v[128:131]
global_load_dwordx4 a[124:127], v7, s[50:51] offset:3072 sc1
ds_write_b128 v22, v[92:95] offset:7168
v_mfma_f32_16x16x32_bf16 v[112:115], v[200:203], a[48:51], v[112:115]
v_mfma_f32_16x16x32_bf16 v[132:135], v[200:203], a[52:55], v[132:135]
ds_write_b128 v22, v[96:99] offset:8192
v_mfma_f32_16x16x32_bf16 v[116:119], v[204:207], a[48:51], v[116:119]
global_load_dwordx4 a[148:151], v2, s[52:53] offset:0 sc1
v_mfma_f32_16x16x32_bf16 v[136:139], v[204:207], a[52:55], v[136:139]
ds_write_b128 v22, v[100:103] offset:9216
v_mfma_f32_16x16x32_bf16 v[120:123], v[208:211], a[48:51], v[120:123]
v_mfma_f32_16x16x32_bf16 v[140:143], v[208:211], a[52:55], v[140:143]
s_waitcnt vmcnt(11)
v_mfma_f32_16x16x32_bf16 v[104:107], v[212:215], a[56:59], v[104:107]
global_load_dwordx4 a[152:155], v7, s[52:53] offset:0 sc1
v_mfma_f32_16x16x32_bf16 v[124:127], v[212:215], a[60:63], v[124:127]
v_mfma_f32_16x16x32_bf16 v[108:111], v[216:219], a[56:59], v[108:111]
v_mfma_f32_16x16x32_bf16 v[128:131], v[216:219], a[60:63], v[128:131]
v_mfma_f32_16x16x32_bf16 v[112:115], v[220:223], a[56:59], v[112:115]
global_load_dwordx4 a[176:179], v2, s[52:53] offset:1024 sc1
s_waitcnt lgkmcnt(0)
s_barrier
v_mfma_f32_16x16x32_bf16 v[132:135], v[220:223], a[60:63], v[132:135]
ds_read_b128 v[64:67], v23 offset:0
v_mfma_f32_16x16x32_bf16 v[116:119], v[224:227], a[56:59], v[116:119]
ds_read_b128 v[68:71], v23 offset:1024
ds_read_b128 v[72:75], v24 offset:0
v_mfma_f32_16x16x32_bf16 v[136:139], v[224:227], a[60:63], v[136:139]
ds_read_b128 v[76:79], v23 offset:10240
ds_read_b128 v[80:83], v23 offset:11264
v_mfma_f32_16x16x32_bf16 v[120:123], v[228:231], a[56:59], v[120:123]
global_load_dwordx4 a[180:183], v7, s[52:53] offset:1024 sc1
ds_read_b128 v[84:87], v24 offset:10240
v_mfma_f32_16x16x32_bf16 v[140:143], v[228:231], a[60:63], v[140:143]
ds_read_b128 v[88:91], v23 offset:20480
s_waitcnt vmcnt(12)
v_mfma_f32_16x16x32_bf16 v[104:107], v[232:235], a[64:67], v[104:107]
ds_read_b128 v[92:95], v23 offset:21504
ds_read_b128 v[96:99], v24 offset:20480
v_mfma_f32_16x16x32_bf16 v[124:127], v[232:235], a[68:71], v[124:127]
ds_read_b128 v[162:165], v23 offset:30720
ds_read_b128 v[166:169], v23 offset:31744
v_mfma_f32_16x16x32_bf16 v[108:111], v[236:239], a[64:67], v[108:111]
global_load_dwordx4 a[204:207], v2, s[52:53] offset:2048 sc1
ds_read_b128 v[100:103], v24 offset:30720
v_mfma_f32_16x16x32_bf16 v[128:131], v[236:239], a[68:71], v[128:131]
v_mfma_f32_16x16x32_bf16 v[112:115], v[240:243], a[64:67], v[112:115]
v_mfma_f32_16x16x32_bf16 v[132:135], v[240:243], a[68:71], v[132:135]
v_mfma_f32_16x16x32_bf16 v[116:119], v[244:247], a[64:67], v[116:119]
global_load_dwordx4 a[208:211], v7, s[52:53] offset:2048 sc1
v_mfma_f32_16x16x32_bf16 v[136:139], v[244:247], a[68:71], v[136:139]
v_mfma_f32_16x16x32_bf16 v[120:123], v[248:251], a[64:67], v[120:123]
v_mfma_f32_16x16x32_bf16 v[140:143], v[248:251], a[68:71], v[140:143]
s_waitcnt vmcnt(12)
v_mfma_f32_16x16x32_bf16 v[104:107], a[240:243], a[72:75], v[104:107]
global_load_dwordx4 a[232:235], v2, s[52:53] offset:3072 sc1
s_waitcnt lgkmcnt(0)
s_barrier
s_nop 0
v_mfma_f32_16x16x32_bf16 v[124:127], a[240:243], a[76:79], v[124:127]
v_mfma_f32_16x16x32_bf16 v[108:111], a[244:247], a[72:75], v[108:111]
v_add_f32 v150, v150, v64
v_add_f32 v151, v151, v65
v_mfma_f32_16x16x32_bf16 v[128:131], a[244:247], a[76:79], v[128:131]
v_add_f32 v152, v152, v66
v_add_f32 v153, v153, v67
v_mfma_f32_16x16x32_bf16 v[112:115], a[248:251], a[72:75], v[112:115]
global_load_dwordx4 a[236:239], v7, s[52:53] offset:3072 sc1
v_add_f32 v154, v154, v68
v_mfma_f32_16x16x32_bf16 v[132:135], a[248:251], a[76:79], v[132:135]
v_add_f32 v155, v155, v69
v_add_f32 v156, v156, v70
v_mfma_f32_16x16x32_bf16 v[116:119], a[252:255], a[72:75], v[116:119]
v_add_f32 v157, v157, v71
v_add_f32 v158, v158, v72
v_mfma_f32_16x16x32_bf16 v[136:139], a[252:255], a[76:79], v[136:139]
v_add_f32 v159, v159, v73
v_add_f32 v160, v160, v74
v_mfma_f32_16x16x32_bf16 v[120:123], a[0:3], a[72:75], v[120:123]
v_add_f32 v161, v161, v75
v_add_f32 v150, v150, v76
v_mfma_f32_16x16x32_bf16 v[140:143], a[0:3], a[76:79], v[140:143]
v_add_f32 v151, v151, v77
s_waitcnt vmcnt(12)
v_mfma_f32_16x16x32_bf16 v[104:107], a[4:7], a[80:83], v[104:107]
v_add_f32 v152, v152, v78
v_add_f32 v153, v153, v79
v_mfma_f32_16x16x32_bf16 v[124:127], a[4:7], a[84:87], v[124:127]
v_add_f32 v154, v154, v80
v_add_f32 v155, v155, v81
v_mfma_f32_16x16x32_bf16 v[108:111], a[8:11], a[80:83], v[108:111]
v_add_f32 v156, v156, v82
v_add_f32 v157, v157, v83
v_mfma_f32_16x16x32_bf16 v[128:131], a[8:11], a[84:87], v[128:131]
v_add_f32 v158, v158, v84
v_add_f32 v159, v159, v85
v_mfma_f32_16x16x32_bf16 v[112:115], a[12:15], a[80:83], v[112:115]
v_add_f32 v160, v160, v86
v_add_f32 v161, v161, v87
v_mfma_f32_16x16x32_bf16 v[132:135], a[12:15], a[84:87], v[132:135]
v_add_f32 v150, v150, v88
v_add_f32 v151, v151, v89
v_mfma_f32_16x16x32_bf16 v[116:119], a[16:19], a[80:83], v[116:119]
v_add_f32 v152, v152, v90
v_add_f32 v153, v153, v91
v_mfma_f32_16x16x32_bf16 v[136:139], a[16:19], a[84:87], v[136:139]
v_add_f32 v154, v154, v92
v_add_f32 v155, v155, v93
v_mfma_f32_16x16x32_bf16 v[120:123], a[20:23], a[80:83], v[120:123]
v_add_f32 v156, v156, v94
v_add_f32 v157, v157, v95
v_mfma_f32_16x16x32_bf16 v[140:143], a[20:23], a[84:87], v[140:143]
v_add_f32 v158, v158, v96
s_waitcnt vmcnt(10)
v_mfma_f32_16x16x32_bf16 v[104:107], a[24:27], a[92:95], v[104:107]
v_add_f32 v159, v159, v97
v_add_f32 v160, v160, v98
v_mfma_f32_16x16x32_bf16 v[124:127], a[24:27], a[96:99], v[124:127]
v_add_f32 v161, v161, v99
v_add_f32 v150, v150, v162
v_mfma_f32_16x16x32_bf16 v[108:111], a[28:31], a[92:95], v[108:111]
v_add_f32 v151, v151, v163
v_add_f32 v152, v152, v164
v_mfma_f32_16x16x32_bf16 v[128:131], a[28:31], a[96:99], v[128:131]
v_add_f32 v153, v153, v165
v_add_f32 v154, v154, v166
v_mfma_f32_16x16x32_bf16 v[112:115], a[32:35], a[92:95], v[112:115]
v_add_f32 v155, v155, v167
v_add_f32 v156, v156, v168
v_mfma_f32_16x16x32_bf16 v[132:135], a[32:35], a[96:99], v[132:135]
v_add_f32 v157, v157, v169
v_add_f32 v158, v158, v100
v_mfma_f32_16x16x32_bf16 v[116:119], a[36:39], a[92:95], v[116:119]
v_add_f32 v159, v159, v101
v_add_f32 v160, v160, v102
v_mfma_f32_16x16x32_bf16 v[136:139], a[36:39], a[96:99], v[136:139]
v_add_f32 v161, v161, v103
v_cvt_pk_bf16_f32 v144, v150, v151
v_mfma_f32_16x16x32_bf16 v[120:123], a[88:91], a[92:95], v[120:123]
v_cvt_pk_bf16_f32 v145, v152, v153
v_cvt_pk_bf16_f32 v146, v154, v155
v_mfma_f32_16x16x32_bf16 v[140:143], a[88:91], a[96:99], v[140:143]
v_cvt_pk_bf16_f32 v147, v156, v157
s_waitcnt vmcnt(8)
v_mfma_f32_16x16x32_bf16 v[104:107], a[100:103], a[120:123], v[104:107]
v_cvt_pk_bf16_f32 v148, v158, v159
v_cvt_pk_bf16_f32 v149, v160, v161
v_mfma_f32_16x16x32_bf16 v[124:127], a[100:103], a[124:127], v[124:127]
global_store_dwordx4 v27, v[144:147], s[16:17] sc1
v_mfma_f32_16x16x32_bf16 v[108:111], a[104:107], a[120:123], v[108:111]
s_mov_b64 exec, s[22:23]
global_store_dwordx2 v28, v[148:149], s[16:17] sc1
s_mov_b64 exec, -1
v_mfma_f32_16x16x32_bf16 v[128:131], a[104:107], a[124:127], v[128:131]
v_mfma_f32_16x16x32_bf16 v[112:115], a[108:111], a[120:123], v[112:115]
s_add_u32 s16, s16, 1310720
s_addc_u32 s17, s17, 0
v_mfma_f32_16x16x32_bf16 v[132:135], a[108:111], a[124:127], v[132:135]
v_mfma_f32_16x16x32_bf16 v[116:119], a[112:115], a[120:123], v[116:119]
v_mfma_f32_16x16x32_bf16 v[136:139], a[112:115], a[124:127], v[136:139]
v_mfma_f32_16x16x32_bf16 v[120:123], a[116:119], a[120:123], v[120:123]
v_mfma_f32_16x16x32_bf16 v[140:143], a[116:119], a[124:127], v[140:143]
s_waitcnt vmcnt(2)
v_mfma_f32_16x16x32_bf16 v[104:107], a[128:131], a[148:151], v[104:107]
v_mfma_f32_16x16x32_bf16 v[104:107], a[156:159], a[176:179], v[104:107]
v_mfma_f32_16x16x32_bf16 v[104:107], a[184:187], a[204:207], v[104:107]
v_mfma_f32_16x16x32_bf16 v[104:107], a[212:215], a[232:235], v[104:107]
v_mfma_f32_16x16x32_bf16 v[108:111], a[132:135], a[148:151], v[108:111]
v_mfma_f32_16x16x32_bf16 v[108:111], a[160:163], a[176:179], v[108:111]
v_mfma_f32_16x16x32_bf16 v[108:111], a[188:191], a[204:207], v[108:111]
s_nop 4
ds_write_b128 v22, v[104:107] offset:0
v_mfma_f32_16x16x32_bf16 v[108:111], a[216:219], a[232:235], v[108:111]
v_mfma_f32_16x16x32_bf16 v[112:115], a[136:139], a[148:151], v[112:115]
v_mfma_f32_16x16x32_bf16 v[112:115], a[164:167], a[176:179], v[112:115]
v_mfma_f32_16x16x32_bf16 v[112:115], a[192:195], a[204:207], v[112:115]
s_nop 4
ds_write_b128 v22, v[108:111] offset:1024
v_mfma_f32_16x16x32_bf16 v[112:115], a[220:223], a[232:235], v[112:115]
v_mfma_f32_16x16x32_bf16 v[116:119], a[140:143], a[148:151], v[116:119]
v_mfma_f32_16x16x32_bf16 v[116:119], a[168:171], a[176:179], v[116:119]
v_mfma_f32_16x16x32_bf16 v[116:119], a[196:199], a[204:207], v[116:119]
s_nop 4
ds_write_b128 v22, v[112:115] offset:2048
v_mfma_f32_16x16x32_bf16 v[116:119], a[224:227], a[232:235], v[116:119]
v_mfma_f32_16x16x32_bf16 v[120:123], a[144:147], a[148:151], v[120:123]
v_mfma_f32_16x16x32_bf16 v[120:123], a[172:175], a[176:179], v[120:123]
v_mfma_f32_16x16x32_bf16 v[120:123], a[200:203], a[204:207], v[120:123]
s_nop 4
ds_write_b128 v22, v[116:119] offset:3072
v_mfma_f32_16x16x32_bf16 v[120:123], a[228:231], a[232:235], v[120:123]
v_mfma_f32_16x16x32_bf16 v[124:127], a[128:131], a[152:155], v[124:127]
v_mfma_f32_16x16x32_bf16 v[124:127], a[156:159], a[180:183], v[124:127]
v_mfma_f32_16x16x32_bf16 v[124:127], a[184:187], a[208:211], v[124:127]
s_nop 4
ds_write_b128 v22, v[120:123] offset:4096
v_mfma_f32_16x16x32_bf16 v[124:127], a[212:215], a[236:239], v[124:127]
v_mfma_f32_16x16x32_bf16 v[128:131], a[132:135], a[152:155], v[128:131]
v_mfma_f32_16x16x32_bf16 v[128:131], a[160:163], a[180:183], v[128:131]
v_mfma_f32_16x16x32_bf16 v[128:131], a[188:191], a[208:211], v[128:131]
s_nop 4
ds_write_b128 v22, v[124:127] offset:5120
v_mfma_f32_16x16x32_bf16 v[128:131], a[216:219], a[236:239], v[128:131]
v_mfma_f32_16x16x32_bf16 v[132:135], a[136:139], a[152:155], v[132:135]
v_mfma_f32_16x16x32_bf16 v[132:135], a[164:167], a[180:183], v[132:135]
v_mfma_f32_16x16x32_bf16 v[132:135], a[192:195], a[208:211], v[132:135]
s_nop 4
ds_write_b128 v22, v[128:131] offset:6144
v_mfma_f32_16x16x32_bf16 v[132:135], a[220:223], a[236:239], v[132:135]
v_mfma_f32_16x16x32_bf16 v[136:139], a[140:143], a[152:155], v[136:139]
v_mfma_f32_16x16x32_bf16 v[136:139], a[168:171], a[180:183], v[136:139]
v_mfma_f32_16x16x32_bf16 v[136:139], a[196:199], a[208:211], v[136:139]
s_nop 4
ds_write_b128 v22, v[132:135] offset:7168
v_mfma_f32_16x16x32_bf16 v[136:139], a[224:227], a[236:239], v[136:139]
v_mfma_f32_16x16x32_bf16 v[140:143], a[144:147], a[152:155], v[140:143]
v_mfma_f32_16x16x32_bf16 v[140:143], a[172:175], a[180:183], v[140:143]
v_mfma_f32_16x16x32_bf16 v[140:143], a[200:203], a[208:211], v[140:143]
s_nop 4
ds_write_b128 v22, v[136:139] offset:8192
v_mfma_f32_16x16x32_bf16 v[140:143], a[228:231], a[236:239], v[140:143]
s_nop 7
ds_write_b128 v22, v[140:143] offset:9216
s_mov_b32 s6, 0
L36_g2c:
v_cmp_u_f32 vcc, v104, v124
s_cbranch_vccnz L35_g2r
L37_g2g:
s_waitcnt lgkmcnt(0)
s_barrier
ds_read_b128 v[64:67], v23 offset:0
ds_read_b128 v[68:71], v23 offset:1024
ds_read_b128 v[72:75], v24 offset:0
ds_read_b128 v[76:79], v23 offset:10240
ds_read_b128 v[80:83], v23 offset:11264
ds_read_b128 v[84:87], v24 offset:10240
ds_read_b128 v[88:91], v23 offset:20480
ds_read_b128 v[92:95], v23 offset:21504
ds_read_b128 v[96:99], v24 offset:20480
ds_read_b128 v[162:165], v23 offset:30720
ds_read_b128 v[166:169], v23 offset:31744
ds_read_b128 v[100:103], v24 offset:30720
s_waitcnt lgkmcnt(9)
v_pk_add_f32 v[36:37], v[36:37], v[64:65]
v_pk_add_f32 v[38:39], v[38:39], v[66:67]
v_pk_add_f32 v[40:41], v[40:41], v[68:69]
v_pk_add_f32 v[42:43], v[42:43], v[70:71]
v_pk_add_f32 v[44:45], v[44:45], v[72:73]
v_pk_add_f32 v[46:47], v[46:47], v[74:75]
s_waitcnt lgkmcnt(6)
v_pk_add_f32 v[36:37], v[36:37], v[76:77]
v_pk_add_f32 v[38:39], v[38:39], v[78:79]
v_pk_add_f32 v[40:41], v[40:41], v[80:81]
v_pk_add_f32 v[42:43], v[42:43], v[82:83]
v_pk_add_f32 v[44:45], v[44:45], v[84:85]
v_pk_add_f32 v[46:47], v[46:47], v[86:87]
s_waitcnt lgkmcnt(3)
v_pk_add_f32 v[36:37], v[36:37], v[88:89]
v_pk_add_f32 v[38:39], v[38:39], v[90:91]
v_pk_add_f32 v[40:41], v[40:41], v[92:93]
v_pk_add_f32 v[42:43], v[42:43], v[94:95]
v_pk_add_f32 v[44:45], v[44:45], v[96:97]
v_pk_add_f32 v[46:47], v[46:47], v[98:99]
s_waitcnt lgkmcnt(0)
v_pk_add_f32 v[36:37], v[36:37], v[162:163]
v_pk_add_f32 v[38:39], v[38:39], v[164:165]
v_pk_add_f32 v[40:41], v[40:41], v[166:167]
v_pk_add_f32 v[42:43], v[42:43], v[168:169]
v_pk_add_f32 v[44:45], v[44:45], v[100:101]
v_pk_add_f32 v[46:47], v[46:47], v[102:103]
v_cvt_pk_bf16_f32 v144, v36, v37
v_cvt_pk_bf16_f32 v145, v38, v39
v_cvt_pk_bf16_f32 v146, v40, v41
v_cvt_pk_bf16_f32 v147, v42, v43
v_cvt_pk_bf16_f32 v148, v44, v45
v_cvt_pk_bf16_f32 v149, v46, v47
global_store_dwordx4 v27, v[144:147], s[16:17] sc1
s_mov_b64 exec, s[22:23]
global_store_dwordx2 v28, v[148:149], s[16:17] sc1
s_mov_b64 exec, -1
s_or_b32 s65, s2, s3
s_cmp_lg_u32 s65, 0
s_cbranch_scc1 L38_ne
v_mov_b32 v4, s42
global_store_dword v6, v4, s[40:41] sc1
L38_ne:
L_exit:
s_endpgm
L16_xr:
s_add_u32 s6, s6, 1
s_cmp_ge_u32 s6, 100000
s_cbranch_scc1 L15_xok
s_sleep 4
global_load_dwordx4 v[64:67], v1, s[48:49] offset:-4096 sc1
global_load_dwordx4 v[68:71], v1, s[48:49] offset:0 sc1
s_add_u32 s70, s48, 8192
s_addc_u32 s71, s49, 0
global_load_dwordx4 v[72:75], v1, s[70:71] offset:-4096 sc1
global_load_dwordx4 v[76:79], v1, s[70:71] offset:0 sc1
s_add_u32 s70, s48, 16384
s_addc_u32 s71, s49, 0
global_load_dwordx4 v[80:83], v1, s[70:71] offset:-4096 sc1
global_load_dwordx4 v[84:87], v1, s[70:71] offset:0 sc1
s_add_u32 s70, s48, 24576
s_addc_u32 s71, s49, 0
global_load_dwordx4 v[88:91], v1, s[70:71] offset:-4096 sc1
global_load_dwordx4 v[92:95], v1, s[70:71] offset:0 sc1
s_waitcnt vmcnt(0)
s_branch L14_xw
L22_fw:
s_add_u32 s6, s6, 1
s_cmp_ge_u32 s6, 100000
s_cbranch_scc1 L23_fok
s_sleep 2
global_load_dword v60, v14, s[58:59] offset:0 sc1
s_waitcnt vmcnt(0)
v_cmp_ne_u32 vcc, v60, v8
s_cbranch_vccnz L22_fw
s_branch L23_fok
L24_w2w:
s_add_u32 s64, s64, 1
s_cmp_ge_u32 s64, 100000
s_cbranch_scc1 L25_w2ok
s_sleep 2
global_load_dwordx4 v[44:47], v30, s[0:1] sc1
s_waitcnt vmcnt(0)
v_xor_b32 v44, v44, v8
v_xor_b32 v45, v45, v8
v_xor_b32 v46, v46, v8
v_xor_b32 v47, v47, v8
v_or3_b32 v44, v44, v45, v46
v_or_b32 v44, v44, v47
v_cmp_ne_u32 vcc, 0, v44
s_cbranch_vccnz L24_w2w
s_branch L25_w2ok
L27_redo:
s_add_u32 s6, s6, 1
s_cmp_ge_u32 s6, 2000
s_cbranch_scc1 L28_go
s_sleep 4
s_add_u32 m0, s60, 0
s_nop 0
global_load_lds_dwordx4 v21, s[54:55] offset:0 sc1
global_load_lds_dwordx4 v21, s[54:55] offset:1024 sc1
global_load_lds_dwordx4 v21, s[54:55] offset:2048 sc1
global_load_lds_dwordx4 v21, s[54:55] offset:3072 sc1
s_add_u32 m0, s60, 4096
s_add_u32 s70, s54, 4096
s_addc_u32 s71, s55, 0
global_load_lds_dwordx4 v21, s[70:71] offset:0 sc1
global_load_lds_dwordx4 v21, s[70:71] offset:1024 sc1
global_load_lds_dwordx4 v21, s[70:71] offset:2048 sc1
global_load_lds_dwordx4 v21, s[70:71] offset:3072 sc1
s_add_u32 m0, s60, 8192
s_add_u32 s70, s54, 8192
s_addc_u32 s71, s55, 0
global_load_lds_dwordx4 v21, s[70:71] offset:0 sc1
global_load_lds_dwordx4 v21, s[70:71] offset:1024 sc1
s_waitcnt vmcnt(0) lgkmcnt(0)
s_nop 7
s_branch L26_stage
L30_redo:
s_add_u32 s6, s6, 1
s_cmp_ge_u32 s6, 2000
s_cbranch_scc1 L31_go
s_sleep 4
s_add_u32 m0, s60, 47904
s_nop 0
global_load_lds_dwordx4 v21, s[54:55] offset:0 sc1
global_load_lds_dwordx4 v21, s[54:55] offset:1024 sc1
global_load_lds_dwordx4 v21, s[54:55] offset:2048 sc1
global_load_lds_dwordx4 v21, s[54:55] offset:3072 sc1
s_add_u32 m0, s60, 52000
s_add_u32 s70, s54, 4096
s_addc_u32 s71, s55, 0
global_load_lds_dwordx4 v21, s[70:71] offset:0 sc1
global_load_lds_dwordx4 v21, s[70:71] offset:1024 sc1
global_load_lds_dwordx4 v21, s[70:71] offset:2048 sc1
global_load_lds_dwordx4 v21, s[70:71] offset:3072 sc1
s_add_u32 m0, s60, 56096
s_add_u32 s70, s54, 8192
s_addc_u32 s71, s55, 0
global_load_lds_dwordx4 v21, s[70:71] offset:0 sc1
global_load_lds_dwordx4 v21, s[70:71] offset:1024 sc1
s_waitcnt vmcnt(0) lgkmcnt(0)
s_barrier
ds_read_b64_tr_b16 v[88:89], v12 offset:47904
ds_read_b64_tr_b16 v[90:91], v12 offset:48160
ds_read_b64_tr_b16 v[92:93], v13 offset:47904
ds_read_b64_tr_b16 v[94:95], v13 offset:48160
ds_read_b64_tr_b16 v[96:97], v12 offset:49952
ds_read_b64_tr_b16 v[98:99], v12 offset:50208
ds_read_b64_tr_b16 v[100:101], v13 offset:49952
ds_read_b64_tr_b16 v[102:103], v13 offset:50208
ds_read_b64_tr_b16 v[104:105], v12 offset:52000
ds_read_b64_tr_b16 v[106:107], v12 offset:52256
ds_read_b64_tr_b16 v[108:109], v13 offset:52000
ds_read_b64_tr_b16 v[110:111], v13 offset:52256
s_waitcnt lgkmcnt(0)
v_mfma_f32_16x16x32_bf16 v[136:139], v[120:123], v[88:91], 0
ds_read_b64_tr_b16 v[112:113], v12 offset:54048
v_mfma_f32_16x16x32_bf16 v[140:143], v[88:91], v[88:91], 0
ds_read_b64_tr_b16 v[114:115], v12 offset:54304
v_mfma_f32_16x16x32_bf16 v[144:147], v[120:123], v[92:95], 0
ds_read_b64_tr_b16 v[116:117], v13 offset:54048
v_mfma_f32_16x16x32_bf16 v[148:151], v[92:95], v[92:95], 0
ds_read_b64_tr_b16 v[118:119], v13 offset:54304
s_waitcnt lgkmcnt(0)
v_mfma_f32_16x16x32_bf16 v[136:139], v[120:123], v[96:99], v[136:139]
ds_read_b64_tr_b16 v[88:89], v12 offset:56096
v_mfma_f32_16x16x32_bf16 v[140:143], v[96:99], v[96:99], v[140:143]
ds_read_b64_tr_b16 v[90:91], v12 offset:56352
v_mfma_f32_16x16x32_bf16 v[144:147], v[120:123], v[100:103], v[144:147]
ds_read_b64_tr_b16 v[92:93], v13 offset:56096
v_mfma_f32_16x16x32_bf16 v[148:151], v[100:103], v[100:103], v[148:151]
ds_read_b64_tr_b16 v[94:95], v13 offset:56352
s_waitcnt lgkmcnt(0)
v_mfma_f32_16x16x32_bf16 v[136:139], v[120:123], v[104:107], v[136:139]
v_mfma_f32_16x16x32_bf16 v[140:143], v[104:107], v[104:107], v[140:143]
v_mfma_f32_16x16x32_bf16 v[144:147], v[120:123], v[108:111], v[144:147]
v_mfma_f32_16x16x32_bf16 v[148:151], v[108:111], v[108:111], v[148:151]
s_waitcnt lgkmcnt(0)
v_mfma_f32_16x16x32_bf16 v[136:139], v[120:123], v[112:115], v[136:139]
v_mfma_f32_16x16x32_bf16 v[140:143], v[112:115], v[112:115], v[140:143]
v_mfma_f32_16x16x32_bf16 v[144:147], v[120:123], v[116:119], v[144:147]
v_mfma_f32_16x16x32_bf16 v[148:151], v[116:119], v[116:119], v[148:151]
s_waitcnt lgkmcnt(0)
v_mfma_f32_16x16x32_bf16 v[136:139], v[120:123], v[88:91], v[136:139]
v_mfma_f32_16x16x32_bf16 v[140:143], v[88:91], v[88:91], v[140:143]
v_mfma_f32_16x16x32_bf16 v[144:147], v[120:123], v[92:95], v[144:147]
v_mfma_f32_16x16x32_bf16 v[148:151], v[92:95], v[92:95], v[148:151]
v_lshrrev_b32 v4, 4, v2
v_and_b32 v4, 3, v4
v_cmp_eq_u32 vcc, 1, v4
s_nop 2
v_cndmask_b32 v140, v140, v141, vcc
s_nop 0
v_cndmask_b32 v148, v148, v149, vcc
v_cmp_eq_u32 vcc, 2, v4
s_nop 1
v_cndmask_b32 v140, v140, v142, vcc
v_cndmask_b32 v148, v148, v150, vcc
v_cmp_eq_u32 vcc, 3, v4
s_nop 1
v_cndmask_b32 v140, v140, v143, vcc
v_cndmask_b32 v148, v148, v151, vcc
v_mov_b32 v137, v140
ds_write_b64 v17, v[136:137] offset:0
v_mov_b32 v145, v148
ds_write_b64 v17, v[144:145] offset:512
s_waitcnt lgkmcnt(0)
s_barrier
ds_read_b128 v[136:139], v18 offset:0
ds_read_b128 v[140:143], v18 offset:16
ds_read_b128 v[144:147], v18 offset:512
ds_read_b128 v[148:151], v18 offset:528
s_waitcnt lgkmcnt(0)
v_pk_add_f32 v[136:137], v[136:137], v[138:139]
v_pk_add_f32 v[140:141], v[140:141], v[142:143]
v_pk_add_f32 v[40:41], v[136:137], v[140:141]
v_pk_add_f32 v[144:145], v[144:145], v[146:147]
v_pk_add_f32 v[148:149], v[148:149], v[150:151]
v_pk_add_f32 v[42:43], v[144:145], v[148:149]
ds_read_b64_tr_b16 v[88:89], v38 offset:0
ds_read_b64_tr_b16 v[90:91], v38 offset:256
ds_read_b64_tr_b16 v[92:93], v39 offset:0
ds_read_b64_tr_b16 v[94:95], v39 offset:256
ds_read_b64_tr_b16 v[96:97], v38 offset:2048
ds_read_b64_tr_b16 v[98:99], v38 offset:2304
ds_read_b64_tr_b16 v[100:101], v39 offset:2048
ds_read_b64_tr_b16 v[102:103], v39 offset:2304
ds_read_b64_tr_b16 v[104:105], v38 offset:4096
ds_read_b64_tr_b16 v[106:107], v38 offset:4352
ds_read_b64_tr_b16 v[108:109], v39 offset:4096
ds_read_b64_tr_b16 v[110:111], v39 offset:4352
s_branch L29_stage
L32_g2r:
s_add_u32 s6, s6, 1
s_cmp_ge_u32 s6, 2000
s_cbranch_scc1 L34_g2g
s_waitcnt vmcnt(0) lgkmcnt(0)
s_sleep 2
global_load_dwordx4 a[40:43], v2, s[8:9] offset:0 sc1
global_load_dwordx4 a[44:47], v7, s[8:9] offset:0 sc1
global_load_dwordx4 a[48:51], v2, s[8:9] offset:1024 sc1
global_load_dwordx4 a[52:55], v7, s[8:9] offset:1024 sc1
global_load_dwordx4 a[56:59], v2, s[8:9] offset:2048 sc1
global_load_dwordx4 a[60:63], v7, s[8:9] offset:2048 sc1
global_load_dwordx4 a[64:67], v2, s[8:9] offset:3072 sc1
global_load_dwordx4 a[68:71], v7, s[8:9] offset:3072 sc1
global_load_dwordx4 a[72:75], v2, s[10:11] offset:0 sc1
global_load_dwordx4 a[76:79], v7, s[10:11] offset:0 sc1
global_load_dwordx4 a[80:83], v2, s[10:11] offset:1024 sc1
global_load_dwordx4 a[84:87], v7, s[10:11] offset:1024 sc1
global_load_dwordx4 a[92:95], v2, s[10:11] offset:2048 sc1
global_load_dwordx4 a[96:99], v7, s[10:11] offset:2048 sc1
global_load_dwordx4 a[120:123], v2, s[10:11] offset:3072 sc1
global_load_dwordx4 a[124:127], v7, s[10:11] offset:3072 sc1
global_load_dwordx4 a[148:151], v2, s[12:13] offset:0 sc1
global_load_dwordx4 a[152:155], v7, s[12:13] offset:0 sc1
global_load_dwordx4 a[176:179], v2, s[12:13] offset:1024 sc1
global_load_dwordx4 a[180:183], v7, s[12:13] offset:1024 sc1
global_load_dwordx4 a[204:207], v2, s[12:13] offset:2048 sc1
global_load_dwordx4 a[208:211], v7, s[12:13] offset:2048 sc1
global_load_dwordx4 a[232:235], v2, s[12:13] offset:3072 sc1
global_load_dwordx4 a[236:239], v7, s[12:13] offset:3072 sc1
s_waitcnt vmcnt(0)
v_mfma_f32_16x16x32_bf16 v[64:67], v[172:175], a[40:43], 0
v_mfma_f32_16x16x32_bf16 v[84:87], v[172:175], a[44:47], 0
v_mfma_f32_16x16x32_bf16 v[68:71], v[176:179], a[40:43], 0
v_mfma_f32_16x16x32_bf16 v[88:91], v[176:179], a[44:47], 0
v_mfma_f32_16x16x32_bf16 v[72:75], v[180:183], a[40:43], 0
v_mfma_f32_16x16x32_bf16 v[92:95], v[180:183], a[44:47], 0
v_mfma_f32_16x16x32_bf16 v[76:79], v[184:187], a[40:43], 0
v_mfma_f32_16x16x32_bf16 v[96:99], v[184:187], a[44:47], 0
v_mfma_f32_16x16x32_bf16 v[80:83], v[188:191], a[40:43], 0
v_mfma_f32_16x16x32_bf16 v[100:103], v[188:191], a[44:47], 0
v_mfma_f32_16x16x32_bf16 v[64:67], v[192:195], a[48:51], v[64:67]
v_mfma_f32_16x16x32_bf16 v[84:87], v[192:195], a[52:55], v[84:87]
v_mfma_f32_16x16x32_bf16 v[68:71], v[196:199], a[48:51], v[68:71]
v_mfma_f32_16x16x32_bf16 v[88:91], v[196:199], a[52:55], v[88:91]
v_mfma_f32_16x16x32_bf16 v[72:75], v[200:203], a[48:51], v[72:75]
v_mfma_f32_16x16x32_bf16 v[92:95], v[200:203], a[52:55], v[92:95]
v_mfma_f32_16x16x32_bf16 v[76:79], v[204:207], a[48:51], v[76:79]
v_mfma_f32_16x16x32_bf16 v[96:99], v[204:207], a[52:55], v[96:99]
v_mfma_f32_16x16x32_bf16 v[80:83], v[208:211], a[48:51], v[80:83]
v_mfma_f32_16x16x32_bf16 v[100:103], v[208:211], a[52:55], v[100:103]
v_mfma_f32_16x16x32_bf16 v[64:67], v[212:215], a[56:59], v[64:67]
v_mfma_f32_16x16x32_bf16 v[84:87], v[212:215], a[60:63], v[84:87]
v_mfma_f32_16x16x32_bf16 v[68:71], v[216:219], a[56:59], v[68:71]
v_mfma_f32_16x16x32_bf16 v[88:91], v[216:219], a[60:63], v[88:91]
v_mfma_f32_16x16x32_bf16 v[72:75], v[220:223], a[56:59], v[72:75]
v_mfma_f32_16x16x32_bf16 v[92:95], v[220:223], a[60:63], v[92:95]
v_mfma_f32_16x16x32_bf16 v[76:79], v[224:227], a[56:59], v[76:79]
v_mfma_f32_16x16x32_bf16 v[96:99], v[224:227], a[60:63], v[96:99]
v_mfma_f32_16x16x32_bf16 v[80:83], v[228:231], a[56:59], v[80:83]
v_mfma_f32_16x16x32_bf16 v[100:103], v[228:231], a[60:63], v[100:103]
v_mfma_f32_16x16x32_bf16 v[64:67], v[232:235], a[64:67], v[64:67]
v_mfma_f32_16x16x32_bf16 v[84:87], v[232:235], a[68:71], v[84:87]
v_mfma_f32_16x16x32_bf16 v[68:71], v[236:239], a[64:67], v[68:71]
v_mfma_f32_16x16x32_bf16 v[88:91], v[236:239], a[68:71], v[88:91]
v_mfma_f32_16x16x32_bf16 v[72:75], v[240:243], a[64:67], v[72:75]
v_mfma_f32_16x16x32_bf16 v[92:95], v[240:243], a[68:71], v[92:95]
v_mfma_f32_16x16x32_bf16 v[76:79], v[244:247], a[64:67], v[76:79]
v_mfma_f32_16x16x32_bf16 v[96:99], v[244:247], a[68:71], v[96:99]
v_mfma_f32_16x16x32_bf16 v[80:83], v[248:251], a[64:67], v[80:83]
v_mfma_f32_16x16x32_bf16 v[100:103], v[248:251], a[68:71], v[100:103]
v_mfma_f32_16x16x32_bf16 v[64:67], a[240:243], a[72:75], v[64:67]
v_mfma_f32_16x16x32_bf16 v[84:87], a[240:243], a[76:79], v[84:87]
v_mfma_f32_16x16x32_bf16 v[68:71], a[244:247], a[72:75], v[68:71]
v_mfma_f32_16x16x32_bf16 v[88:91], a[244:247], a[76:79], v[88:91]
v_mfma_f32_16x16x32_bf16 v[72:75], a[248:251], a[72:75], v[72:75]
v_mfma_f32_16x16x32_bf16 v[92:95], a[248:251], a[76:79], v[92:95]
v_mfma_f32_16x16x32_bf16 v[76:79], a[252:255], a[72:75], v[76:79]
v_mfma_f32_16x16x32_bf16 v[96:99], a[252:255], a[76:79], v[96:99]
v_mfma_f32_16x16x32_bf16 v[80:83], a[0:3], a[72:75], v[80:83]
v_mfma_f32_16x16x32_bf16 v[100:103], a[0:3], a[76:79], v[100:103]
v_mfma_f32_16x16x32_bf16 v[64:67], a[4:7], a[80:83], v[64:67]
v_mfma_f32_16x16x32_bf16 v[84:87], a[4:7], a[84:87], v[84:87]
v_mfma_f32_16x16x32_bf16 v[68:71], a[8:11], a[80:83], v[68:71]
v_mfma_f32_16x16x32_bf16 v[88:91], a[8:11], a[84:87], v[88:91]
v_mfma_f32_16x16x32_bf16 v[72:75], a[12:15], a[80:83], v[72:75]
v_mfma_f32_16x16x32_bf16 v[92:95], a[12:15], a[84:87], v[92:95]
v_mfma_f32_16x16x32_bf16 v[76:79], a[16:19], a[80:83], v[76:79]
v_mfma_f32_16x16x32_bf16 v[96:99], a[16:19], a[84:87], v[96:99]
v_mfma_f32_16x16x32_bf16 v[80:83], a[20:23], a[80:83], v[80:83]
v_mfma_f32_16x16x32_bf16 v[100:103], a[20:23], a[84:87], v[100:103]
v_mfma_f32_16x16x32_bf16 v[64:67], a[24:27], a[92:95], v[64:67]
v_mfma_f32_16x16x32_bf16 v[84:87], a[24:27], a[96:99], v[84:87]
v_mfma_f32_16x16x32_bf16 v[68:71], a[28:31], a[92:95], v[68:71]
v_mfma_f32_16x16x32_bf16 v[88:91], a[28:31], a[96:99], v[88:91]
v_mfma_f32_16x16x32_bf16 v[72:75], a[32:35], a[92:95], v[72:75]
v_mfma_f32_16x16x32_bf16 v[92:95], a[32:35], a[96:99], v[92:95]
v_mfma_f32_16x16x32_bf16 v[76:79], a[36:39], a[92:95], v[76:79]
v_mfma_f32_16x16x32_bf16 v[96:99], a[36:39], a[96:99], v[96:99]
v_mfma_f32_16x16x32_bf16 v[80:83], a[88:91], a[92:95], v[80:83]
v_mfma_f32_16x16x32_bf16 v[100:103], a[88:91], a[96:99], v[100:103]
v_mfma_f32_16x16x32_bf16 v[64:67], a[100:103], a[120:123], v[64:67]
v_mfma_f32_16x16x32_bf16 v[84:87], a[100:103], a[124:127], v[84:87]
v_mfma_f32_16x16x32_bf16 v[68:71], a[104:107], a[120:123], v[68:71]
v_mfma_f32_16x16x32_bf16 v[88:91], a[104:107], a[124:127], v[88:91]
v_mfma_f32_16x16x32_bf16 v[72:75], a[108:111], a[120:123], v[72:75]
v_mfma_f32_16x16x32_bf16 v[92:95], a[108:111], a[124:127], v[92:95]
v_mfma_f32_16x16x32_bf16 v[76:79], a[112:115], a[120:123], v[76:79]
v_mfma_f32_16x16x32_bf16 v[96:99], a[112:115], a[124:127], v[96:99]
v_mfma_f32_16x16x32_bf16 v[80:83], a[116:119], a[120:123], v[80:83]
v_mfma_f32_16x16x32_bf16 v[100:103], a[116:119], a[124:127], v[100:103]
v_mfma_f32_16x16x32_bf16 v[64:67], a[128:131], a[148:151], v[64:67]
v_mfma_f32_16x16x32_bf16 v[84:87], a[128:131], a[152:155], v[84:87]
v_mfma_f32_16x16x32_bf16 v[68:71], a[132:135], a[148:151], v[68:71]
v_mfma_f32_16x16x32_bf16 v[88:91], a[132:135], a[152:155], v[88:91]
v_mfma_f32_16x16x32_bf16 v[72:75], a[136:139], a[148:151], v[72:75]
v_mfma_f32_16x16x32_bf16 v[92:95], a[136:139], a[152:155], v[92:95]
v_mfma_f32_16x16x32_bf16 v[76:79], a[140:143], a[148:151], v[76:79]
v_mfma_f32_16x16x32_bf16 v[96:99], a[140:143], a[152:155], v[96:99]
v_mfma_f32_16x16x32_bf16 v[80:83], a[144:147], a[148:151], v[80:83]
v_mfma_f32_16x16x32_bf16 v[100:103], a[144:147], a[152:155], v[100:103]
v_mfma_f32_16x16x32_bf16 v[64:67], a[156:159], a[176:179], v[64:67]
v_mfma_f32_16x16x32_bf16 v[84:87], a[156:159], a[180:183], v[84:87]
v_mfma_f32_16x16x32_bf16 v[68:71], a[160:163], a[176:179], v[68:71]
v_mfma_f32_16x16x32_bf16 v[88:91], a[160:163], a[180:183], v[88:91]
v_mfma_f32_16x16x32_bf16 v[72:75], a[164:167], a[176:179], v[72:75]
v_mfma_f32_16x16x32_bf16 v[92:95], a[164:167], a[180:183], v[92:95]
v_mfma_f32_16x16x32_bf16 v[76:79], a[168:171], a[176:179], v[76:79]
v_mfma_f32_16x16x32_bf16 v[96:99], a[168:171], a[180:183], v[96:99]
v_mfma_f32_16x16x32_bf16 v[80:83], a[172:175], a[176:179], v[80:83]
v_mfma_f32_16x16x32_bf16 v[100:103], a[172:175], a[180:183], v[100:103]
v_mfma_f32_16x16x32_bf16 v[64:67], a[184:187], a[204:207], v[64:67]
v_mfma_f32_16x16x32_bf16 v[84:87], a[184:187], a[208:211], v[84:87]
v_mfma_f32_16x16x32_bf16 v[68:71], a[188:191], a[204:207], v[68:71]
v_mfma_f32_16x16x32_bf16 v[88:91], a[188:191], a[208:211], v[88:91]
v_mfma_f32_16x16x32_bf16 v[72:75], a[192:195], a[204:207], v[72:75]
v_mfma_f32_16x16x32_bf16 v[92:95], a[192:195], a[208:211], v[92:95]
v_mfma_f32_16x16x32_bf16 v[76:79], a[196:199], a[204:207], v[76:79]
v_mfma_f32_16x16x32_bf16 v[96:99], a[196:199], a[208:211], v[96:99]
v_mfma_f32_16x16x32_bf16 v[80:83], a[200:203], a[204:207], v[80:83]
v_mfma_f32_16x16x32_bf16 v[100:103], a[200:203], a[208:211], v[100:103]
v_mfma_f32_16x16x32_bf16 v[64:67], a[212:215], a[232:235], v[64:67]
v_mfma_f32_16x16x32_bf16 v[84:87], a[212:215], a[236:239], v[84:87]
v_mfma_f32_16x16x32_bf16 v[68:71], a[216:219], a[232:235], v[68:71]
v_mfma_f32_16x16x32_bf16 v[88:91], a[216:219], a[236:239], v[88:91]
v_mfma_f32_16x16x32_bf16 v[72:75], a[220:223], a[232:235], v[72:75]
v_mfma_f32_16x16x32_bf16 v[92:95], a[220:223], a[236:239], v[92:95]
v_mfma_f32_16x16x32_bf16 v[76:79], a[224:227], a[232:235], v[76:79]
v_mfma_f32_16x16x32_bf16 v[96:99], a[224:227], a[236:239], v[96:99]
v_mfma_f32_16x16x32_bf16 v[80:83], a[228:231], a[232:235], v[80:83]
v_mfma_f32_16x16x32_bf16 v[100:103], a[228:231], a[236:239], v[100:103]
global_load_dwordx4 a[40:43], v2, s[48:49] offset:0 sc1
global_load_dwordx4 a[44:47], v7, s[48:49] offset:0 sc1
global_load_dwordx4 a[48:51], v2, s[48:49] offset:1024 sc1
global_load_dwordx4 a[52:55], v7, s[48:49] offset:1024 sc1
global_load_dwordx4 a[56:59], v2, s[48:49] offset:2048 sc1
global_load_dwordx4 a[60:63], v7, s[48:49] offset:2048 sc1
global_load_dwordx4 a[64:67], v2, s[48:49] offset:3072 sc1
global_load_dwordx4 a[68:71], v7, s[48:49] offset:3072 sc1
global_load_dwordx4 a[72:75], v2, s[50:51] offset:0 sc1
global_load_dwordx4 a[76:79], v7, s[50:51] offset:0 sc1
global_load_dwordx4 a[80:83], v2, s[50:51] offset:1024 sc1
global_load_dwordx4 a[84:87], v7, s[50:51] offset:1024 sc1
s_waitcnt vmcnt(0)
s_nop 7
s_branch L33_g2c
L35_g2r:
s_add_u32 s6, s6, 1
s_cmp_ge_u32 s6, 2000
s_cbranch_scc1 L37_g2g
s_waitcnt vmcnt(0) lgkmcnt(0)
s_sleep 2
global_load_dwordx4 a[40:43], v2, s[48:49] offset:0 sc1
global_load_dwordx4 a[44:47], v7, s[48:49] offset:0 sc1
global_load_dwordx4 a[48:51], v2, s[48:49] offset:1024 sc1
global_load_dwordx4 a[52:55], v7, s[48:49] offset:1024 sc1
global_load_dwordx4 a[56:59], v2, s[48:49] offset:2048 sc1
global_load_dwordx4 a[60:63], v7, s[48:49] offset:2048 sc1
global_load_dwordx4 a[64:67], v2, s[48:49] offset:3072 sc1
global_load_dwordx4 a[68:71], v7, s[48:49] offset:3072 sc1
global_load_dwordx4 a[72:75], v2, s[50:51] offset:0 sc1
global_load_dwordx4 a[76:79], v7, s[50:51] offset:0 sc1
global_load_dwordx4 a[80:83], v2, s[50:51] offset:1024 sc1
global_load_dwordx4 a[84:87], v7, s[50:51] offset:1024 sc1
global_load_dwordx4 a[92:95], v2, s[50:51] offset:2048 sc1
global_load_dwordx4 a[96:99], v7, s[50:51] offset:2048 sc1
global_load_dwordx4 a[120:123], v2, s[50:51] offset:3072 sc1
global_load_dwordx4 a[124:127], v7, s[50:51] offset:3072 sc1
global_load_dwordx4 a[148:151], v2, s[52:53] offset:0 sc1
global_load_dwordx4 a[152:155], v7, s[52:53] offset:0 sc1
global_load_dwordx4 a[176:179], v2, s[52:53] offset:1024 sc1
global_load_dwordx4 a[180:183], v7, s[52:53] offset:1024 sc1
global_load_dwordx4 a[204:207], v2, s[52:53] offset:2048 sc1
global_load_dwordx4 a[208:211], v7, s[52:53] offset:2048 sc1
global_load_dwordx4 a[232:235], v2, s[52:53] offset:3072 sc1
global_load_dwordx4 a[236:239], v7, s[52:53] offset:3072 sc1
s_waitcnt vmcnt(0)
v_mfma_f32_16x16x32_bf16 v[104:107], v[172:175], a[40:43], 0
v_mfma_f32_16x16x32_bf16 v[124:127], v[172:175], a[44:47], 0
v_mfma_f32_16x16x32_bf16 v[108:111], v[176:179], a[40:43], 0
v_mfma_f32_16x16x32_bf16 v[128:131], v[176:179], a[44:47], 0
v_mfma_f32_16x16x32_bf16 v[112:115], v[180:183], a[40:43], 0
v_mfma_f32_16x16x32_bf16 v[132:135], v[180:183], a[44:47], 0
v_mfma_f32_16x16x32_bf16 v[116:119], v[184:187], a[40:43], 0
v_mfma_f32_16x16x32_bf16 v[136:139], v[184:187], a[44:47], 0
v_mfma_f32_16x16x32_bf16 v[120:123], v[188:191], a[40:43], 0
v_mfma_f32_16x16x32_bf16 v[140:143], v[188:191], a[44:47], 0
v_mfma_f32_16x16x32_bf16 v[104:107], v[192:195], a[48:51], v[104:107]
v_mfma_f32_16x16x32_bf16 v[124:127], v[192:195], a[52:55], v[124:127]
v_mfma_f32_16x16x32_bf16 v[108:111], v[196:199], a[48:51], v[108:111]
v_mfma_f32_16x16x32_bf16 v[128:131], v[196:199], a[52:55], v[128:131]
v_mfma_f32_16x16x32_bf16 v[112:115], v[200:203], a[48:51], v[112:115]
v_mfma_f32_16x16x32_bf16 v[132:135], v[200:203], a[52:55], v[132:135]
v_mfma_f32_16x16x32_bf16 v[116:119], v[204:207], a[48:51], v[116:119]
v_mfma_f32_16x16x32_bf16 v[136:139], v[204:207], a[52:55], v[136:139]
v_mfma_f32_16x16x32_bf16 v[120:123], v[208:211], a[48:51], v[120:123]
v_mfma_f32_16x16x32_bf16 v[140:143], v[208:211], a[52:55], v[140:143]
v_mfma_f32_16x16x32_bf16 v[104:107], v[212:215], a[56:59], v[104:107]
v_mfma_f32_16x16x32_bf16 v[124:127], v[212:215], a[60:63], v[124:127]
v_mfma_f32_16x16x32_bf16 v[108:111], v[216:219], a[56:59], v[108:111]
v_mfma_f32_16x16x32_bf16 v[128:131], v[216:219], a[60:63], v[128:131]
v_mfma_f32_16x16x32_bf16 v[112:115], v[220:223], a[56:59], v[112:115]
v_mfma_f32_16x16x32_bf16 v[132:135], v[220:223], a[60:63], v[132:135]
v_mfma_f32_16x16x32_bf16 v[116:119], v[224:227], a[56:59], v[116:119]
v_mfma_f32_16x16x32_bf16 v[136:139], v[224:227], a[60:63], v[136:139]
v_mfma_f32_16x16x32_bf16 v[120:123], v[228:231], a[56:59], v[120:123]
v_mfma_f32_16x16x32_bf16 v[140:143], v[228:231], a[60:63], v[140:143]
v_mfma_f32_16x16x32_bf16 v[104:107], v[232:235], a[64:67], v[104:107]
v_mfma_f32_16x16x32_bf16 v[124:127], v[232:235], a[68:71], v[124:127]
v_mfma_f32_16x16x32_bf16 v[108:111], v[236:239], a[64:67], v[108:111]
v_mfma_f32_16x16x32_bf16 v[128:131], v[236:239], a[68:71], v[128:131]
v_mfma_f32_16x16x32_bf16 v[112:115], v[240:243], a[64:67], v[112:115]
v_mfma_f32_16x16x32_bf16 v[132:135], v[240:243], a[68:71], v[132:135]
v_mfma_f32_16x16x32_bf16 v[116:119], v[244:247], a[64:67], v[116:119]
v_mfma_f32_16x16x32_bf16 v[136:139], v[244:247], a[68:71], v[136:139]
v_mfma_f32_16x16x32_bf16 v[120:123], v[248:251], a[64:67], v[120:123]
v_mfma_f32_16x16x32_bf16 v[140:143], v[248:251], a[68:71], v[140:143]
v_mfma_f32_16x16x32_bf16 v[104:107], a[240:243], a[72:75], v[104:107]
v_mfma_f32_16x16x32_bf16 v[124:127], a[240:243], a[76:79], v[124:127]
v_mfma_f32_16x16x32_bf16 v[108:111], a[244:247], a[72:75], v[108:111]
v_mfma_f32_16x16x32_bf16 v[128:131], a[244:247], a[76:79], v[128:131]
v_mfma_f32_16x16x32_bf16 v[112:115], a[248:251], a[72:75], v[112:115]
v_mfma_f32_16x16x32_bf16 v[132:135], a[248:251], a[76:79], v[132:135]
v_mfma_f32_16x16x32_bf16 v[116:119], a[252:255], a[72:75], v[116:119]
v_mfma_f32_16x16x32_bf16 v[136:139], a[252:255], a[76:79], v[136:139]
v_mfma_f32_16x16x32_bf16 v[120:123], a[0:3], a[72:75], v[120:123]
v_mfma_f32_16x16x32_bf16 v[140:143], a[0:3], a[76:79], v[140:143]
v_mfma_f32_16x16x32_bf16 v[104:107], a[4:7], a[80:83], v[104:107]
v_mfma_f32_16x16x32_bf16 v[124:127], a[4:7], a[84:87], v[124:127]
v_mfma_f32_16x16x32_bf16 v[108:111], a[8:11], a[80:83], v[108:111]
v_mfma_f32_16x16x32_bf16 v[128:131], a[8:11], a[84:87], v[128:131]
v_mfma_f32_16x16x32_bf16 v[112:115], a[12:15], a[80:83], v[112:115]
v_mfma_f32_16x16x32_bf16 v[132:135], a[12:15], a[84:87], v[132:135]
v_mfma_f32_16x16x32_bf16 v[116:119], a[16:19], a[80:83], v[116:119]
v_mfma_f32_16x16x32_bf16 v[136:139], a[16:19], a[84:87], v[136:139]
v_mfma_f32_16x16x32_bf16 v[120:123], a[20:23], a[80:83], v[120:123]
v_mfma_f32_16x16x32_bf16 v[140:143], a[20:23], a[84:87], v[140:143]
v_mfma_f32_16x16x32_bf16 v[104:107], a[24:27], a[92:95], v[104:107]
v_mfma_f32_16x16x32_bf16 v[124:127], a[24:27], a[96:99], v[124:127]
v_mfma_f32_16x16x32_bf16 v[108:111], a[28:31], a[92:95], v[108:111]
v_mfma_f32_16x16x32_bf16 v[128:131], a[28:31], a[96:99], v[128:131]
v_mfma_f32_16x16x32_bf16 v[112:115], a[32:35], a[92:95], v[112:115]
v_mfma_f32_16x16x32_bf16 v[132:135], a[32:35], a[96:99], v[132:135]
v_mfma_f32_16x16x32_bf16 v[116:119], a[36:39], a[92:95], v[116:119]
v_mfma_f32_16x16x32_bf16 v[136:139], a[36:39], a[96:99], v[136:139]
v_mfma_f32_16x16x32_bf16 v[120:123], a[88:91], a[92:95], v[120:123]
v_mfma_f32_16x16x32_bf16 v[140:143], a[88:91], a[96:99], v[140:143]
v_mfma_f32_16x16x32_bf16 v[104:107], a[100:103], a[120:123], v[104:107]
v_mfma_f32_16x16x32_bf16 v[124:127], a[100:103], a[124:127], v[124:127]
v_mfma_f32_16x16x32_bf16 v[108:111], a[104:107], a[120:123], v[108:111]
v_mfma_f32_16x16x32_bf16 v[128:131], a[104:107], a[124:127], v[128:131]
v_mfma_f32_16x16x32_bf16 v[112:115], a[108:111], a[120:123], v[112:115]
v_mfma_f32_16x16x32_bf16 v[132:135], a[108:111], a[124:127], v[132:135]
v_mfma_f32_16x16x32_bf16 v[116:119], a[112:115], a[120:123], v[116:119]
v_mfma_f32_16x16x32_bf16 v[136:139], a[112:115], a[124:127], v[136:139]
v_mfma_f32_16x16x32_bf16 v[120:123], a[116:119], a[120:123], v[120:123]
v_mfma_f32_16x16x32_bf16 v[140:143], a[116:119], a[124:127], v[140:143]
v_mfma_f32_16x16x32_bf16 v[104:107], a[128:131], a[148:151], v[104:107]
v_mfma_f32_16x16x32_bf16 v[124:127], a[128:131], a[152:155], v[124:127]
v_mfma_f32_16x16x32_bf16 v[108:111], a[132:135], a[148:151], v[108:111]
v_mfma_f32_16x16x32_bf16 v[128:131], a[132:135], a[152:155], v[128:131]
v_mfma_f32_16x16x32_bf16 v[112:115], a[136:139], a[148:151], v[112:115]
v_mfma_f32_16x16x32_bf16 v[132:135], a[136:139], a[152:155], v[132:135]
v_mfma_f32_16x16x32_bf16 v[116:119], a[140:143], a[148:151], v[116:119]
v_mfma_f32_16x16x32_bf16 v[136:139], a[140:143], a[152:155], v[136:139]
v_mfma_f32_16x16x32_bf16 v[120:123], a[144:147], a[148:151], v[120:123]
v_mfma_f32_16x16x32_bf16 v[140:143], a[144:147], a[152:155], v[140:143]
v_mfma_f32_16x16x32_bf16 v[104:107], a[156:159], a[176:179], v[104:107]
v_mfma_f32_16x16x32_bf16 v[124:127], a[156:159], a[180:183], v[124:127]
v_mfma_f32_16x16x32_bf16 v[108:111], a[160:163], a[176:179], v[108:111]
v_mfma_f32_16x16x32_bf16 v[128:131], a[160:163], a[180:183], v[128:131]
v_mfma_f32_16x16x32_bf16 v[112:115], a[164:167], a[176:179], v[112:115]
v_mfma_f32_16x16x32_bf16 v[132:135], a[164:167], a[180:183], v[132:135]
v_mfma_f32_16x16x32_bf16 v[116:119], a[168:171], a[176:179], v[116:119]
v_mfma_f32_16x16x32_bf16 v[136:139], a[168:171], a[180:183], v[136:139]
v_mfma_f32_16x16x32_bf16 v[120:123], a[172:175], a[176:179], v[120:123]
v_mfma_f32_16x16x32_bf16 v[140:143], a[172:175], a[180:183], v[140:143]
v_mfma_f32_16x16x32_bf16 v[104:107], a[184:187], a[204:207], v[104:107]
v_mfma_f32_16x16x32_bf16 v[124:127], a[184:187], a[208:211], v[124:127]
v_mfma_f32_16x16x32_bf16 v[108:111], a[188:191], a[204:207], v[108:111]
v_mfma_f32_16x16x32_bf16 v[128:131], a[188:191], a[208:211], v[128:131]
v_mfma_f32_16x16x32_bf16 v[112:115], a[192:195], a[204:207], v[112:115]
v_mfma_f32_16x16x32_bf16 v[132:135], a[192:195], a[208:211], v[132:135]
v_mfma_f32_16x16x32_bf16 v[116:119], a[196:199], a[204:207], v[116:119]
v_mfma_f32_16x16x32_bf16 v[136:139], a[196:199], a[208:211], v[136:139]
v_mfma_f32_16x16x32_bf16 v[120:123], a[200:203], a[204:207], v[120:123]
v_mfma_f32_16x16x32_bf16 v[140:143], a[200:203], a[208:211], v[140:143]
v_mfma_f32_16x16x32_bf16 v[104:107], a[212:215], a[232:235], v[104:107]
v_mfma_f32_16x16x32_bf16 v[124:127], a[212:215], a[236:239], v[124:127]
v_mfma_f32_16x16x32_bf16 v[108:111], a[216:219], a[232:235], v[108:111]
v_mfma_f32_16x16x32_bf16 v[128:131], a[216:219], a[236:239], v[128:131]
v_mfma_f32_16x16x32_bf16 v[112:115], a[220:223], a[232:235], v[112:115]
v_mfma_f32_16x16x32_bf16 v[132:135], a[220:223], a[236:239], v[132:135]
v_mfma_f32_16x16x32_bf16 v[116:119], a[224:227], a[232:235], v[116:119]
v_mfma_f32_16x16x32_bf16 v[136:139], a[224:227], a[236:239], v[136:139]
v_mfma_f32_16x16x32_bf16 v[120:123], a[228:231], a[232:235], v[120:123]
v_mfma_f32_16x16x32_bf16 v[140:143], a[228:231], a[236:239], v[140:143]
ds_write_b128 v22, v[104:107] offset:0
ds_write_b128 v22, v[108:111] offset:1024
s_nop 0
ds_write_b128 v22, v[112:115] offset:2048
s_nop 0
ds_write_b128 v22, v[116:119] offset:3072
s_nop 0
ds_write_b128 v22, v[120:123] offset:4096
ds_write_b128 v22, v[124:127] offset:5120
ds_write_b128 v22, v[128:131] offset:6144
ds_write_b128 v22, v[132:135] offset:7168
ds_write_b128 v22, v[136:139] offset:8192
ds_write_b128 v22, v[140:143] offset:9216
s_nop 7
s_branch L36_g2c
.p2align 8
L_table:
.long 0,40960,40960,0
.long 8,40992,40992,16
.long 16,41024,41024,32
.long 24,41056,41056,48
.long 64,42112,41088,64
.long 72,42144,41120,80
.long 80,42176,41152,96
.long 88,42208,41184,112
.long 128,42240,41216,128
.long 136,42272,41248,144
.long 144,42304,41280,160
.long 152,42336,41312,176
.long 192,42368,41344,192
.long 200,42400,41376,208
.long 208,42432,41408,224
.long 216,42464,41440,240
.long 544,41984,40960,256
.long 552,42016,40992,272
.long 560,42048,41024,288
.long 568,42080,41056,304
.long 608,41088,41088,320
.long 616,41120,41120,336
.long 624,41152,41152,352
.long 632,41184,41184,368
.long 672,42240,41216,384
.long 680,42272,41248,400
.long 688,42304,41280,416
.long 696,42336,41312,432
.long 736,42368,41344,448
.long 744,42400,41376,464
.long 752,42432,41408,480
.long 760,42464,41440,496
.long 1024,41984,40960,512
.long 1032,42016,40992,528
.long 1040,42048,41024,544
.long 1048,42080,41056,560
.long 1088,42112,41088,576
.long 1096,42144,41120,592
.long 1104,42176,41152,608
.long 1112,42208,41184,624
.long 1152,41216,41216,640
.long 1160,41248,41248,656
.long 1168,41280,41280,672
.long 1176,41312,41312,688
.long 1216,42368,41344,704
.long 1224,42400,41376,720
.long 1232,42432,41408,736
.long 1240,42464,41440,752
.long 1568,41984,40960,768
.long 1576,42016,40992,784
.long 1584,42048,41024,800
.long 1592,42080,41056,816
.long 1632,42112,41088,832
.long 1640,42144,41120,848
.long 1648,42176,41152,864
.long 1656,42208,41184,880
.long 1696,42240,41216,896
.long 1704,42272,41248,912
.long 1712,42304,41280,928
.long 1720,42336,41312,944
.long 1760,41344,41344,960
.long 1768,41376,41376,976
.long 1776,41408,41408,992
.long 1784,41440,41440,1008
.long 0,40968,40960,1024
.long 8,41000,40992,1040
.long 16,41032,41024,1056
.long 24,41064,41056,1072
.long 64,42120,41088,1088
.long 72,42152,41120,1104
.long 80,42184,41152,1120
.long 88,42216,41184,1136
.long 128,42248,41216,1152
.long 136,42280,41248,1168
.long 144,42312,41280,1184
.long 152,42344,41312,1200
.long 192,42376,41344,1216
.long 200,42408,41376,1232
.long 208,42440,41408,1248
.long 216,42472,41440,1264
.long 544,41992,40960,1280
.long 552,42024,40992,1296
.long 560,42056,41024,1312
.long 568,42088,41056,1328
.long 608,41096,41088,1344
.long 616,41128,41120,1360
.long 624,41160,41152,1376
.long 632,41192,41184,1392
.long 672,42248,41216,1408
.long 680,42280,41248,1424
.long 688,42312,41280,1440
.long 696,42344,41312,1456
.long 736,42376,41344,1472
.long 744,42408,41376,1488
.long 752,42440,41408,1504
.long 760,42472,41440,1520
.long 1024,41992,40960,1536
.long 1032,42024,40992,1552
.long 1040,42056,41024,1568
.long 1048,42088,41056,1584
.long 1088,42120,41088,1600
.long 1096,42152,41120,1616
.long 1104,42184,41152,1632
.long 1112,42216,41184,1648
.long 1152,41224,41216,1664
.long 1160,41256,41248,1680
.long 1168,41288,41280,1696
.long 1176,41320,41312,1712
.long 1216,42376,41344,1728
.long 1224,42408,41376,1744
.long 1232,42440,41408,1760
.long 1240,42472,41440,1776
.long 1568,41992,40960,1792
.long 1576,42024,40992,1808
.long 1584,42056,41024,1824
.long 1592,42088,41056,1840
.long 1632,42120,41088,1856
.long 1640,42152,41120,1872
.long 1648,42184,41152,1888
.long 1656,42216,41184,1904
.long 1696,42248,41216,1920
.long 1704,42280,41248,1936
.long 1712,42312,41280,1952
.long 1720,42344,41312,1968
.long 1760,41352,41344,1984
.long 1768,41384,41376,2000
.long 1776,41416,41408,2016
.long 1784,41448,41440,2032
.long 0,40976,40960,2048
.long 8,41008,40992,2064
.long 16,41040,41024,2080
.long 24,41072,41056,2096
.long 64,42128,41088,2112
.long 72,42160,41120,2128
.long 80,42192,41152,2144
.long 88,42224,41184,2160
.long 128,42256,41216,2176
.long 136,42288,41248,2192
.long 144,42320,41280,2208
.long 152,42352,41312,2224
.long 192,42384,41344,2240
.long 200,42416,41376,2256
.long 208,42448,41408,2272
.long 216,42480,41440,2288
.long 544,42000,40960,2304
.long 552,42032,40992,2320
.long 560,42064,41024,2336
.long 568,42096,41056,2352
.long 608,41104,41088,2368
.long 616,41136,41120,2384
.long 624,41168,41152,2400
.long 632,41200,41184,2416
.long 672,42256,41216,2432
.long 680,42288,41248,2448
.long 688,42320,41280,2464
.long 696,42352,41312,2480
.long 736,42384,41344,2496
.long 744,42416,41376,2512
.long 752,42448,41408,2528
.long 760,42480,41440,2544
.long 1024,42000,40960,2560
.long 1032,42032,40992,2576
.long 1040,42064,41024,2592
.long 1048,42096,41056,2608
.long 1088,42128,41088,2624
.long 1096,42160,41120,2640
.long 1104,42192,41152,2656
.long 1112,42224,41184,2672
.long 1152,41232,41216,2688
.long 1160,41264,41248,2704
.long 1168,41296,41280,2720
.long 1176,41328,41312,2736
.long 1216,42384,41344,2752
.long 1224,42416,41376,2768
.long 1232,42448,41408,2784
.long 1240,42480,41440,2800
.long 1568,42000,40960,2816
.long 1576,42032,40992,2832
.long 1584,42064,41024,2848
.long 1592,42096,41056,2864
.long 1632,42128,41088,2880
.long 1640,42160,41120,2896
.long 1648,42192,41152,2912
.long 1656,42224,41184,2928
.long 1696,42256,41216,2944
.long 1704,42288,41248,2960
.long 1712,42320,41280,2976
.long 1720,42352,41312,2992
.long 1760,41360,41344,3008
.long 1768,41392,41376,3024
.long 1776,41424,41408,3040
.long 1784,41456,41440,3056
.long 0,40984,40960,3072
.long 8,41016,40992,3088
.long 16,41048,41024,3104
.long 24,41080,41056,3120
.long 64,42136,41088,3136
.long 72,42168,41120,3152
.long 80,42200,41152,3168
.long 88,42232,41184,3184
.long 128,42264,41216,3200
.long 136,42296,41248,3216
.long 144,42328,41280,3232
.long 152,42360,41312,3248
.long 192,42392,41344,3264
.long 200,42424,41376,3280
.long 208,42456,41408,3296
.long 216,42488,41440,3312
.long 544,42008,40960,3328
.long 552,42040,40992,3344
.long 560,42072,41024,3360
.long 568,42104,41056,3376
.long 608,41112,41088,3392
.long 616,41144,41120,3408
.long 624,41176,41152,3424
.long 632,41208,41184,3440
.long 672,42264,41216,3456
.long 680,42296,41248,3472
.long 688,42328,41280,3488
.long 696,42360,41312,3504
.long 736,42392,41344,3520
.long 744,42424,41376,3536
.long 752,42456,41408,3552
.long 760,42488,41440,3568
.long 1024,42008,40960,3584
.long 1032,42040,40992,3600
.long 1040,42072,41024,3616
.long 1048,42104,41056,3632
.long 1088,42136,41088,3648
.long 1096,42168,41120,3664
.long 1104,42200,41152,3680
.long 1112,42232,41184,3696
.long 1152,41240,41216,3712
.long 1160,41272,41248,3728
.long 1168,41304,41280,3744
.long 1176,41336,41312,3760
.long 1216,42392,41344,3776
.long 1224,42424,41376,3792
.long 1232,42456,41408,3808
.long 1240,42488,41440,3824
.long 1568,42008,40960,3840
.long 1576,42040,40992,3856
.long 1584,42072,41024,3872
.long 1592,42104,41056,3888
.long 1632,42136,41088,3904
.long 1640,42168,41120,3920
.long 1648,42200,41152,3936
.long 1656,42232,41184,3952
.long 1696,42264,41216,3968
.long 1704,42296,41248,3984
.long 1712,42328,41280,4000
.long 1720,42360,41312,4016
.long 1760,41368,41344,4032
.long 1768,41400,41376,4048
.long 1776,41432,41408,4064
.long 1784,41464,41440,4080
.long 4096,0,97824,97824
.long 4112,16,97840,97840
.long 4128,32,97856,97856
.long 4144,48,97872,97872
.long 4160,64,97888,97888
.long 4176,80,97904,97904
.long 4192,96,97920,97920
.long 4208,112,97936,97936
.long 4224,128,97952,97952
.long 4240,144,97968,97968
.long 4256,160,97984,97984
.long 4272,176,98000,98000
.long 4288,192,98016,98016
.long 4304,208,98032,98032
.long 4320,224,98048,98048
.long 4336,240,98064,98064
.long 4352,256,98080,98080
.long 4368,272,98096,98096
.long 4384,288,98112,98112
.long 4400,304,98128,98128
.long 4416,320,98144,98144
.long 4432,336,98160,98160
.long 4448,352,98176,98176
.long 4464,368,98192,98192
.long 4480,384,98208,98208
.long 4496,400,98224,98224
.long 4512,416,98240,98240
.long 4528,432,98256,98256
.long 4544,448,98272,98272
.long 4560,464,98288,98288
.long 4576,480,98304,98304
.long 4592,496,98320,98320
.long 53248,544,98336,98336
.long 53264,560,98352,98352
.long 53280,512,98368,98368
.long 53296,528,98384,98384
.long 53312,608,98400,98400
.long 53328,624,98416,98416
.long 53344,576,98432,98432
.long 53360,592,98448,98448
.long 53376,672,98464,98464
.long 53392,688,98480,98480
.long 53408,640,98496,98496
.long 53424,656,98512,98512
.long 53440,736,98528,98528
.long 53456,752,98544,98544
.long 53472,704,98560,98560
.long 53488,720,98576,98576
.long 53504,800,98592,98592
.long 53520,816,98608,98608
.long 53536,768,98624,98624
.long 53552,784,98640,98640
.long 53568,864,98656,98656
.long 53584,880,98672,98672
.long 53600,832,98688,98688
.long 53616,848,98704,98704
.long 53632,928,98720,98720
.long 53648,944,98736,98736
.long 53664,896,98752,98752
.long 53680,912,98768,98768
.long 53696,992,98784,98784
.long 53712,1008,98800,98800
.long 53728,960,98816,98816
.long 53744,976,98832,98832
.long 4608,10240,108064,99872
.long 4624,10256,108080,99888
.long 4640,10272,108096,99904
.long 4656,10288,108112,99920
.long 4672,10304,108128,99936
.long 4688,10320,108144,99952
.long 4704,10336,108160,99968
.long 4720,10352,108176,99984
.long 4736,10368,108192,100000
.long 4752,10384,108208,100016
.long 4768,10400,108224,100032
.long 4784,10416,108240,100048
.long 4800,10432,108256,100064
.long 4816,10448,108272,100080
.long 4832,10464,108288,100096
.long 4848,10480,108304,100112
.long 4864,10496,108320,100128
.long 4880,10512,108336,100144
.long 4896,10528,108352,100160
.long 4912,10544,108368,100176
.long 4928,10560,108384,100192
.long 4944,10576,108400,100208
.long 4960,10592,108416,100224
.long 4976,10608,108432,100240
.long 4992,10624,108448,100256
.long 5008,10640,108464,100272
.long 5024,10656,108480,100288
.long 5040,10672,108496,100304
.long 5056,10688,108512,100320
.long 5072,10704,108528,100336
.long 5088,10720,108544,100352
.long 5104,10736,108560,100368
.long 53760,10784,108576,100384
.long 53776,10800,108592,100400
.long 53792,10752,108608,100416
.long 53808,10768,108624,100432
.long 53824,10848,108640,100448
.long 53840,10864,108656,100464
.long 53856,10816,108672,100480
.long 53872,10832,108688,100496
.long 53888,10912,108704,100512
.long 53904,10928,108720,100528
.long 53920,10880,108736,100544
.long 53936,10896,108752,100560
.long 53952,10976,108768,100576
.long 53968,10992,108784,100592
.long 53984,10944,108800,100608
.long 54000,10960,108816,100624
.long 54016,11040,108832,100640
.long 54032,11056,108848,100656
.long 54048,11008,108864,100672
.long 54064,11024,108880,100688
.long 54080,11104,108896,100704
.long 54096,11120,108912,100720
.long 54112,11072,108928,100736
.long 54128,11088,108944,100752
.long 54144,11168,108960,100768
.long 54160,11184,108976,100784
.long 54176,11136,108992,100800
.long 54192,11152,109008,100816
.long 54208,11232,109024,100832
.long 54224,11248,109040,100848
.long 54240,11200,109056,100864
.long 54256,11216,109072,100880
.long 5120,20480,118304,102944
.long 5136,20496,118320,102960
.long 5152,20512,118336,102976
.long 5168,20528,118352,102992
.long 5184,20544,118368,103008
.long 5200,20560,118384,103024
.long 5216,20576,118400,103040
.long 5232,20592,118416,103056
.long 5248,20608,118432,103072
.long 5264,20624,118448,103088
.long 5280,20640,118464,103104
.long 5296,20656,118480,103120
.long 5312,20672,118496,103136
.long 5328,20688,118512,103152
.long 5344,20704,118528,103168
.long 5360,20720,118544,103184
.long 5376,20736,118560,103200
.long 5392,20752,118576,103216
.long 5408,20768,118592,103232
.long 5424,20784,118608,103248
.long 5440,20800,118624,103264
.long 5456,20816,118640,103280
.long 5472,20832,118656,103296
.long 5488,20848,118672,103312
.long 5504,20864,118688,103328
.long 5520,20880,118704,103344
.long 5536,20896,118720,103360
.long 5552,20912,118736,103376
.long 5568,20928,118752,103392
.long 5584,20944,118768,103408
.long 5600,20960,118784,103424
.long 5616,20976,118800,103440
.long 54272,21024,118816,103456
.long 54288,21040,118832,103472
.long 54304,20992,118848,103488
.long 54320,21008,118864,103504
.long 54336,21088,118880,103520
.long 54352,21104,118896,103536
.long 54368,21056,118912,103552
.long 54384,21072,118928,103568
.long 54400,21152,118944,103584
.long 54416,21168,118960,103600
.long 54432,21120,118976,103616
.long 54448,21136,118992,103632
.long 54464,21216,119008,103648
.long 54480,21232,119024,103664
.long 54496,21184,119040,103680
.long 54512,21200,119056,103696
.long 54528,21280,119072,103712
.long 54544,21296,119088,103728
.long 54560,21248,119104,103744
.long 54576,21264,119120,103760
.long 54592,21344,119136,103776
.long 54608,21360,119152,103792
.long 54624,21312,119168,103808
.long 54640,21328,119184,103824
.long 54656,21408,119200,103840
.long 54672,21424,119216,103856
.long 54688,21376,119232,103872
.long 54704,21392,119248,103888
.long 54720,21472,119264,103904
.long 54736,21488,119280,103920
.long 54752,21440,119296,103936
.long 54768,21456,119312,103952
.long 5632,30720,128544,104992
.long 5648,30736,128560,105008
.long 5664,30752,128576,105024
.long 5680,30768,128592,105040
.long 5696,30784,128608,105056
.long 5712,30800,128624,105072
.long 5728,30816,128640,105088
.long 5744,30832,128656,105104
.long 5760,30848,128672,105120
.long 5776,30864,128688,105136
.long 5792,30880,128704,105152
.long 5808,30896,128720,105168
.long 5824,30912,128736,105184
.long 5840,30928,128752,105200
.long 5856,30944,128768,105216
.long 5872,30960,128784,105232
.long 5888,30976,128800,105248
.long 5904,30992,128816,105264
.long 5920,31008,128832,105280
.long 5936,31024,128848,105296
.long 5952,31040,128864,105312
.long 5968,31056,128880,105328
.long 5984,31072,128896,105344
.long 6000,31088,128912,105360
.long 6016,31104,128928,105376
.long 6032,31120,128944,105392
.long 6048,31136,128960,105408
.long 6064,31152,128976,105424
.long 6080,31168,128992,105440
.long 6096,31184,129008,105456
.long 6112,31200,129024,105472
.long 6128,31216,129040,105488
.long 54784,31264,129056,105504
.long 54800,31280,129072,105520
.long 54816,31232,129088,105536
.long 54832,31248,129104,105552
.long 54848,31328,129120,105568
.long 54864,31344,129136,105584
.long 54880,31296,129152,105600
.long 54896,31312,129168,105616
.long 54912,31392,129184,105632
.long 54928,31408,129200,105648
.long 54944,31360,129216,105664
.long 54960,31376,129232,105680
.long 54976,31456,129248,105696
.long 54992,31472,129264,105712
.long 55008,31424,129280,105728
.long 55024,31440,129296,105744
.long 55040,31520,129312,105760
.long 55056,31536,129328,105776
.long 55072,31488,129344,105792
.long 55088,31504,129360,105808
.long 55104,31584,129376,105824
.long 55120,31600,129392,105840
.long 55136,31552,129408,105856
.long 55152,31568,129424,105872
.long 55168,31648,129440,105888
.long 55184,31664,129456,105904
.long 55200,31616,129472,105920
.long 55216,31632,129488,105936
.long 55232,31712,129504,105952
.long 55248,31728,129520,105968
.long 55264,31680,129536,105984
.long 55280,31696,129552,106000
.long 101920,0,4096,0
.long 101936,8,4104,1280
.long 101952,16,4112,2560
.long 101968,24,4120,3840
.long 101984,64,4160,5120
.long 102000,72,4168,6400
.long 102016,80,4176,7680
.long 102032,88,4184,8960
.long 102048,128,4224,10240
.long 102064,136,4232,11520
.long 102080,144,4240,12800
.long 102096,152,4248,14080
.long 102112,192,4288,15360
.long 102128,200,4296,16640
.long 102144,208,4304,17920
.long 102160,216,4312,19200
.long 102176,544,4352,16
.long 102192,552,4360,1296
.long 102208,560,4368,2576
.long 102224,568,4376,3856
.long 102240,608,4416,5136
.long 102256,616,4424,6416
.long 102272,624,4432,7696
.long 102288,632,4440,8976
.long 102304,672,4480,10256
.long 102320,680,4488,11536
.long 102336,688,4496,12816
.long 102352,696,4504,14096
.long 102368,736,4544,15376
.long 102384,744,4552,16656
.long 102400,752,4560,17936
.long 102416,760,4568,19216
.long 102432,1024,4640,32
.long 102448,1032,4648,1312
.long 102464,1040,4656,2592
.long 102480,1048,4664,3872
.long 102496,1088,4704,5152
.long 102512,1096,4712,6432
.long 102528,1104,4720,7712
.long 102544,1112,4728,8992
.long 102560,1152,4768,10272
.long 102576,1160,4776,11552
.long 102592,1168,4784,12832
.long 102608,1176,4792,14112
.long 102624,1216,4832,15392
.long 102640,1224,4840,16672
.long 102656,1232,4848,17952
.long 102672,1240,4856,19232
.long 102688,1568,4896,48
.long 102704,1576,4904,1328
.long 102720,1584,4912,2608
.long 102736,1592,4920,3888
.long 102752,1632,4960,5168
.long 102768,1640,4968,6448
.long 102784,1648,4976,7728
.long 102800,1656,4984,9008
.long 102816,1696,5024,10288
.long 102832,1704,5032,11568
.long 102848,1712,5040,12848
.long 102864,1720,5048,14128
.long 102880,1760,5088,15408
.long 102896,1768,5096,16688
.long 102912,1776,5104,17968
.long 102928,1784,5112,19248
.long 101920,2048,4096,64
.long 101936,2056,4104,1344
.long 101952,2064,4112,2624
.long 101968,2072,4120,3904
.long 101984,2112,4160,5184
.long 102000,2120,4168,6464
.long 102016,2128,4176,7744
.long 102032,2136,4184,9024
.long 102048,2176,4224,10304
.long 102064,2184,4232,11584
.long 102080,2192,4240,12864
.long 102096,2200,4248,14144
.long 102112,2240,4288,15424
.long 102128,2248,4296,16704
.long 102144,2256,4304,17984
.long 102160,2264,4312,19264
.long 102176,2592,4352,80
.long 102192,2600,4360,1360
.long 102208,2608,4368,2640
.long 102224,2616,4376,3920
.long 102240,2656,4416,5200
.long 102256,2664,4424,6480
.long 102272,2672,4432,7760
.long 102288,2680,4440,9040
.long 102304,2720,4480,10320
.long 102320,2728,4488,11600
.long 102336,2736,4496,12880
.long 102352,2744,4504,14160
.long 102368,2784,4544,15440
.long 102384,2792,4552,16720
.long 102400,2800,4560,18000
.long 102416,2808,4568,19280
.long 102432,3072,4640,96
.long 102448,3080,4648,1376
.long 102464,3088,4656,2656
.long 102480,3096,4664,3936
.long 102496,3136,4704,5216
.long 102512,3144,4712,6496
.long 102528,3152,4720,7776
.long 102544,3160,4728,9056
.long 102560,3200,4768,10336
.long 102576,3208,4776,11616
.long 102592,3216,4784,12896
.long 102608,3224,4792,14176
.long 102624,3264,4832,15456
.long 102640,3272,4840,16736
.long 102656,3280,4848,18016
.long 102672,3288,4856,19296
.long 102688,3616,4896,112
.long 102704,3624,4904,1392
.long 102720,3632,4912,2672
.long 102736,3640,4920,3952
.long 102752,3680,4960,5232
.long 102768,3688,4968,6512
.long 102784,3696,4976,7792
.long 102800,3704,4984,9072
.long 102816,3744,5024,10352
.long 102832,3752,5032,11632
.long 102848,3760,5040,12912
.long 102864,3768,5048,14192
.long 102880,3808,5088,15472
.long 102896,3816,5096,16752
.long 102912,3824,5104,18032
.long 102928,3832,5112,19312
.long 107040,32,4128,20480
.long 107056,40,4136,21760
.long 107072,48,4144,23040
.long 107088,56,4152,24320
.long 107104,96,4192,25600
.long 107120,104,4200,26880
.long 107136,112,4208,28160
.long 107152,120,4216,29440
.long 107168,160,4256,30720
.long 107184,168,4264,32000
.long 107200,176,4272,33280
.long 107216,184,4280,34560
.long 107232,224,4320,35840
.long 107248,232,4328,37120
.long 107264,240,4336,38400
.long 107280,248,4344,39680
.long 107296,512,4384,20496
.long 107312,520,4392,21776
.long 107328,528,4400,23056
.long 107344,536,4408,24336
.long 107360,576,4448,25616
.long 107376,584,4456,26896
.long 107392,592,4464,28176
.long 107408,600,4472,29456
.long 107424,640,4512,30736
.long 107440,648,4520,32016
.long 107456,656,4528,33296
.long 107472,664,4536,34576
.long 107488,704,4576,35856
.long 107504,712,4584,37136
.long 107520,720,4592,38416
.long 107536,728,4600,39696
.long 107552,1056,4608,20512
.long 107568,1064,4616,21792
.long 107584,1072,4624,23072
.long 107600,1080,4632,24352
.long 107616,1120,4672,25632
.long 107632,1128,4680,26912
.long 107648,1136,4688,28192
.long 107664,1144,4696,29472
.long 107680,1184,4736,30752
.long 107696,1192,4744,32032
.long 107712,1200,4752,33312
.long 107728,1208,4760,34592
.long 107744,1248,4800,35872
.long 107760,1256,4808,37152
.long 107776,1264,4816,38432
.long 107792,1272,4824,39712
.long 107808,1536,4864,20528
.long 107824,1544,4872,21808
.long 107840,1552,4880,23088
.long 107856,1560,4888,24368
.long 107872,1600,4928,25648
.long 107888,1608,4936,26928
.long 107904,1616,4944,28208
.long 107920,1624,4952,29488
.long 107936,1664,4992,30768
.long 107952,1672,5000,32048
.long 107968,1680,5008,33328
.long 107984,1688,5016,34608
.long 108000,1728,5056,35888
.long 108016,1736,5064,37168
.long 108032,1744,5072,38448
.long 108048,1752,5080,39728
.long 107040,2080,4128,20544
.long 107056,2088,4136,21824
.long 107072,2096,4144,23104
.long 107088,2104,4152,24384
.long 107104,2144,4192,25664
.long 107120,2152,4200,26944
.long 107136,2160,4208,28224
.long 107152,2168,4216,29504
.long 107168,2208,4256,30784
.long 107184,2216,4264,32064
.long 107200,2224,4272,33344
.long 107216,2232,4280,34624
.long 107232,2272,4320,35904
.long 107248,2280,4328,37184
.long 107264,2288,4336,38464
.long 107280,2296,4344,39744
.long 107296,2560,4384,20560
.long 107312,2568,4392,21840
.long 107328,2576,4400,23120
.long 107344,2584,4408,24400
.long 107360,2624,4448,25680
.long 107376,2632,4456,26960
.long 107392,2640,4464,28240
.long 107408,2648,4472,29520
.long 107424,2688,4512,30800
.long 107440,2696,4520,32080
.long 107456,2704,4528,33360
.long 107472,2712,4536,34640
.long 107488,2752,4576,35920
.long 107504,2760,4584,37200
.long 107520,2768,4592,38480
.long 107536,2776,4600,39760
.long 107552,3104,4608,20576
.long 107568,3112,4616,21856
.long 107584,3120,4624,23136
.long 107600,3128,4632,24416
.long 107616,3168,4672,25696
.long 107632,3176,4680,26976
.long 107648,3184,4688,28256
.long 107664,3192,4696,29536
.long 107680,3232,4736,30816
.long 107696,3240,4744,32096
.long 107712,3248,4752,33376
.long 107728,3256,4760,34656
.long 107744,3296,4800,35936
.long 107760,3304,4808,37216
.long 107776,3312,4816,38496
.long 107792,3320,4824,39776
.long 107808,3584,4864,20592
.long 107824,3592,4872,21872
.long 107840,3600,4880,23152
.long 107856,3608,4888,24432
.long 107872,3648,4928,25712
.long 107888,3656,4936,26992
.long 107904,3664,4944,28272
.long 107920,3672,4952,29552
.long 107936,3712,4992,30832
.long 107952,3720,5000,32112
.long 107968,3728,5008,33392
.long 107984,3736,5016,34672
.long 108000,3776,5056,35952
.long 108016,3784,5064,37232
.long 108032,3792,5072,38512
.long 108048,3800,5080,39792
.long 128,0,0,0
.long 1408,4,128,16
.long 2688,8,256,32
.long 3968,12,384,48
.long 5248,1024,512,1280
.long 6528,1028,640,1296
.long 7808,1032,768,1312
.long 9088,1036,896,1328
.long 10368,0,1024,2560
.long 11648,4,1152,2576
.long 12928,8,1280,2592
.long 14208,12,1408,2608
.long 15488,1024,1536,3840
.long 16768,1028,1664,3856
.long 18048,1032,1792,3872
.long 19328,1036,1920,3888
.long 136,0,2048,8
.long 1416,4,2176,24
.long 2696,8,2304,40
.long 3976,12,2432,56
.long 5256,1024,2560,1288
.long 6536,1028,2688,1304
.long 7816,1032,2816,1320
.long 9096,1036,2944,1336
.long 10376,0,3072,2568
.long 11656,4,3200,2584
.long 12936,8,3328,2600
.long 14216,12,3456,2616
.long 15496,1024,3584,3848
.long 16776,1028,3712,3864
.long 18056,1032,3840,3880
.long 19336,1036,3968,3896
.long 144,0,4096,64
.long 1424,4,4224,80
.long 2704,8,4352,96
.long 3984,12,4480,112
.long 5264,1024,4608,1344
.long 6544,1028,4736,1360
.long 7824,1032,4864,1376
.long 9104,1036,4992,1392
.long 10384,0,5120,2624
.long 11664,4,5248,2640
.long 12944,8,5376,2656
.long 14224,12,5504,2672
.long 15504,1024,5632,3904
.long 16784,1028,5760,3920
.long 18064,1032,5888,3936
.long 19344,1036,6016,3952
.long 152,0,6016,72
.long 1432,4,6016,88
.long 2712,8,6016,104
.long 3992,12,6016,120
.long 5272,1024,6016,1352
.long 6552,1028,6016,1368
.long 7832,1032,6016,1384
.long 9112,1036,6016,1400
.long 10392,0,6016,2632
.long 11672,4,6016,2648
.long 12952,8,6016,2664
.long 14232,12,6016,2680
.long 15512,1024,6016,3912
.long 16792,1028,6016,3928
.long 18072,1032,6016,3944
.long 19352,1036,6016,3960
.long 128,2048,6144,128
.long 1408,2052,6272,136
.long 2688,2056,6400,144
.long 3968,2060,6528,152
.long 5248,3072,6656,1408
.long 6528,3076,6784,1416
.long 7808,3080,6912,1424
.long 9088,3084,7040,1432
.long 10368,2048,7168,2688
.long 11648,2052,7296,2696
.long 12928,2056,7424,2704
.long 14208,2060,7552,2712
.long 15488,3072,7680,3968
.long 16768,3076,7808,3976
.long 18048,3080,7936,3984
.long 19328,3084,8064,3992
.long 136,2048,8192,160
.long 1416,2052,8320,176
.long 2696,2056,8448,192
.long 3976,2060,8576,208
.long 5256,3072,8704,1440
.long 6536,3076,8832,1456
.long 7816,3080,8960,1472
.long 9096,3084,9088,1488
.long 10376,2048,9216,2720
.long 11656,2052,9344,2736
.long 12936,2056,9472,2752
.long 14216,2060,9600,2768
.long 15496,3072,9728,4000
.long 16776,3076,9856,4016
.long 18056,3080,9984,4032
.long 19336,3084,10112,4048
.long 144,2048,10240,168
.long 1424,2052,10368,184
.long 2704,2056,10496,200
.long 3984,2060,10624,216
.long 5264,3072,10752,1448
.long 6544,3076,10880,1464
.long 7824,3080,11008,1480
.long 9104,3084,11136,1496
.long 10384,2048,11264,2728
.long 11664,2052,11392,2744
.long 12944,2056,11520,2760
.long 14224,2060,11648,2776
.long 15504,3072,11776,4008
.long 16784,3076,11904,4024
.long 18064,3080,12032,4040
.long 19344,3084,12160,4056
.long 152,2048,12160,224
.long 1432,2052,12160,240
.long 2712,2056,12160,256
.long 3992,2060,12160,272
.long 5272,3072,12160,1504
.long 6552,3076,12160,1520
.long 7832,3080,12160,1536
.long 9112,3084,12160,1552
.long 10392,2048,12160,2784
.long 11672,2052,12160,2800
.long 12952,2056,12160,2816
.long 14232,2060,12160,2832
.long 15512,3072,12160,4064
.long 16792,3076,12160,4080
.long 18072,3080,12160,4096
.long 19352,3084,12160,4112
.long 20608,4096,12288,232
.long 21888,4100,12416,248
.long 23168,4104,12544,264
.long 24448,4108,12672,280
.long 25728,5120,12800,1512
.long 27008,5124,12928,1528
.long 28288,5128,13056,1544
.long 29568,5132,13184,1560
.long 30848,4096,13312,2792
.long 32128,4100,13440,2808
.long 33408,4104,13568,2824
.long 34688,4108,13696,2840
.long 35968,5120,13824,4072
.long 37248,5124,13952,4088
.long 38528,5128,14080,4104
.long 39808,5132,14208,4120
.long 20616,4096,14336,288
.long 21896,4100,14464,296
.long 23176,4104,14592,304
.long 24456,4108,14720,312
.long 25736,5120,14848,1568
.long 27016,5124,14976,1576
.long 28296,5128,15104,1584
.long 29576,5132,15232,1592
.long 30856,4096,15360,2848
.long 32136,4100,15488,2856
.long 33416,4104,15616,2864
.long 34696,4108,15744,2872
.long 35976,5120,15872,4128
.long 37256,5124,16000,4136
.long 38536,5128,16128,4144
.long 39816,5132,16256,4152
.long 20624,4096,16384,320
.long 21904,4100,16512,336
.long 23184,4104,16640,352
.long 24464,4108,16768,368
.long 25744,5120,16896,1600
.long 27024,5124,17024,1616
.long 28304,5128,17152,1632
.long 29584,5132,17280,1648
.long 30864,4096,17408,2880
.long 32144,4100,17536,2896
.long 33424,4104,17664,2912
.long 34704,4108,17792,2928
.long 35984,5120,17920,4160
.long 37264,5124,18048,4176
.long 38544,5128,18176,4192
.long 39824,5132,18304,4208
.long 20632,4096,18304,328
.long 21912,4100,18304,344
.long 23192,4104,18304,360
.long 24472,4108,18304,376
.long 25752,5120,18304,1608
.long 27032,5124,18304,1624
.long 28312,5128,18304,1640
.long 29592,5132,18304,1656
.long 30872,4096,18304,2888
.long 32152,4100,18304,2904
.long 33432,4104,18304,2920
.long 34712,4108,18304,2936
.long 35992,5120,18304,4168
.long 37272,5124,18304,4184
.long 38552,5128,18304,4200
.long 39832,5132,18304,4216
.long 20608,6144,18432,384
.long 21888,6148,18560,400
.long 23168,6152,18688,416
.long 24448,6156,18816,432
.long 25728,7168,18944,1664
.long 27008,7172,19072,1680
.long 28288,7176,19200,1696
.long 29568,7180,19328,1712
.long 30848,6144,19456,2944
.long 32128,6148,19584,2960
.long 33408,6152,19712,2976
.long 34688,6156,19840,2992
.long 35968,7168,19968,4224
.long 37248,7172,20096,4240
.long 38528,7176,20224,4256
.long 39808,7180,20352,4272
.long 20616,6144,20480,392
.long 21896,6148,20608,408
.long 23176,6152,20736,424
.long 24456,6156,20864,440
.long 25736,7168,20992,1672
.long 27016,7172,21120,1688
.long 28296,7176,21248,1704
.long 29576,7180,21376,1720
.long 30856,6144,21504,2952
.long 32136,6148,21632,2968
.long 33416,6152,21760,2984
.long 34696,6156,21888,3000
.long 35976,7168,22016,4232
.long 37256,7172,22144,4248
.long 38536,7176,22272,4264
.long 39816,7180,22400,4280
.long 20624,6144,22528,448
.long 21904,6148,22656,456
.long 23184,6152,22784,464
.long 24464,6156,22912,472
.long 25744,7168,23040,1728
.long 27024,7172,23168,1736
.long 28304,7176,23296,1744
.long 29584,7180,23424,1752
.long 30864,6144,23552,3008
.long 32144,6148,23680,3016
.long 33424,6152,23808,3024
.long 34704,6156,23936,3032
.long 35984,7168,24064,4288
.long 37264,7172,24192,4296
.long 38544,7176,24320,4304
.long 39824,7180,24448,4312
.long 20632,6144,24448,480
.long 21912,6148,24448,496
.long 23192,6152,24448,512
.long 24472,6156,24448,528
.long 25752,7168,24448,1760
.long 27032,7172,24448,1776
.long 28312,7176,24448,1792
.long 29592,7180,24448,1808
.long 30872,6144,24448,3040
.long 32152,6148,24448,3056
.long 33432,6152,24448,3072
.long 34712,6156,24448,3088
.long 35992,7168,24448,4320
.long 37272,7172,24448,4336
.long 38552,7176,24448,4352
.long 39832,7180,24448,4368
.long 488,1024,0,738304
.long 504,1040,16,738320
.long 520,1056,32,738336
.long 536,1072,48,738352
.long 1768,2304,64,738368
.long 1784,2320,80,738384
.long 1800,2336,96,738400
.long 1816,2352,112,738416
.long 3048,3584,128,738432
.long 3064,3600,144,738448
.long 3080,3616,160,738464
.long 3096,3632,176,738480
.long 4328,4864,192,738496
.long 4344,4880,208,738512
.long 4360,4896,224,738528
.long 4376,4912,240,738544
.long 544,1032,1024,739328
.long 560,1048,1040,739344
.long 576,1064,1056,739360
.long 592,1080,1072,739376
.long 1824,2312,1088,739392
.long 1840,2328,1104,739408
.long 1856,2344,1120,739424
.long 1872,2360,1136,739440
.long 3104,3592,1152,739456
.long 3120,3608,1168,739472
.long 3136,3624,1184,739488
.long 3152,3640,1200,739504
.long 4384,4872,1216,739520
.long 4400,4888,1232,739536
.long 4416,4904,1248,739552
.long 4432,4920,1264,739568
.long 552,1088,2048,740352
.long 568,1096,2064,740368
.long 584,1104,2080,740384
.long 600,1112,2096,740400
.long 1832,2368,2112,740416
.long 1848,2376,2128,740432
.long 1864,2384,2144,740448
.long 1880,2392,2160,740464
.long 3112,3648,2176,740480
.long 3128,3656,2192,740496
.long 3144,3664,2208,740512
.long 3160,3672,2224,740528
.long 4392,4928,2240,740544
.long 4408,4936,2256,740560
.long 4424,4944,2272,740576
.long 4440,4952,2288,740592
.long 608,1120,3072,741376
.long 616,1136,3088,741392
.long 624,1152,3104,741408
.long 632,1168,3120,741424
.long 1888,2400,3136,741440
.long 1896,2416,3152,741456
.long 1904,2432,3168,741472
.long 1912,2448,3184,741488
.long 3168,3680,3200,741504
.long 3176,3696,3216,741520
.long 3184,3712,3232,741536
.long 3192,3728,3248,741552
.long 4448,4960,3264,741568
.long 4456,4976,3280,741584
.long 4464,4992,3296,741600
.long 4472,5008,3312,741616
.long 640,1128,4096,983040
.long 656,1144,4112,983056
.long 672,1160,4128,983072
.long 688,1176,4144,983088
.long 1920,2408,4160,983104
.long 1936,2424,4176,983120
.long 1952,2440,4192,983136
.long 1968,2456,4208,983152
.long 3200,3688,4224,983168
.long 3216,3704,4240,983184
.long 3232,3720,4256,983200
.long 3248,3736,4272,983216
.long 4480,4968,4288,983232
.long 4496,4984,4304,983248
.long 4512,5000,4320,983264
.long 4528,5016,4336,983280
.long 648,1184,245760,984064
.long 664,1200,245776,984080
.long 680,1216,245792,984096
.long 696,1232,245808,984112
.long 1928,2464,245824,984128
.long 1944,2480,245840,984144
.long 1960,2496,245856,984160
.long 1976,2512,245872,984176
.long 3208,3744,245888,984192
.long 3224,3760,245904,984208
.long 3240,3776,245920,984224
.long 3256,3792,245936,984240
.long 4488,5024,245952,984256
.long 4504,5040,245968,984272
.long 4520,5056,245984,984288
.long 4536,5072,246000,984304
.long 704,1192,246784,985088
.long 720,1208,246800,985104
.long 736,1224,246816,985120
.long 752,1240,246832,985136
.long 1984,2472,246848,985152
.long 2000,2488,246864,985168
.long 2016,2504,246880,985184
.long 2032,2520,246896,985200
.long 3264,3752,246912,985216
.long 3280,3768,246928,985232
.long 3296,3784,246944,985248
.long 3312,3800,246960,985264
.long 4544,5032,246976,985280
.long 4560,5048,246992,985296
.long 4576,5064,247008,985312
.long 4592,5080,247024,985328
.long 712,1248,247808,986112
.long 728,1256,247824,986128
.long 744,1264,247840,986144
.long 760,1272,247856,986160
.long 1992,2528,247872,986176
.long 2008,2536,247888,986192
.long 2024,2544,247904,986208
.long 2040,2552,247920,986224
.long 3272,3808,247936,986240
.long 3288,3816,247952,986256
.long 3304,3824,247968,986272
.long 3320,3832,247984,986288
.long 4552,5088,248000,986304
.long 4568,5096,248016,986320
.long 4584,5104,248032,986336
.long 4600,5112,248048,986352
.long 768,1024,248832,987136
.long 776,1040,248848,987152
.long 784,1056,248864,987168
.long 792,1072,248880,987184
.long 2048,2304,248896,987200
.long 2056,2320,248912,987216
.long 2064,2336,248928,987232
.long 2072,2352,248944,987248
.long 3328,3584,248960,987264
.long 3336,3600,248976,987280
.long 3344,3616,248992,987296
.long 3352,3632,249008,987312
.long 4608,4864,249024,987328
.long 4616,4880,249040,987344
.long 4624,4896,249056,987360
.long 4632,4912,249072,987376
.long 800,1032,249856,1228800
.long 816,1048,249872,1228816
.long 832,1064,249888,1228832
.long 848,1080,249904,1228848
.long 2080,2312,249920,1228864
.long 2096,2328,249936,1228880
.long 2112,2344,249952,1228896
.long 2128,2360,249968,1228912
.long 3360,3592,249984,1228928
.long 3376,3608,250000,1228944
.long 3392,3624,250016,1228960
.long 3408,3640,250032,1228976
.long 4640,4872,250048,1228992
.long 4656,4888,250064,1229008
.long 4672,4904,250080,1229024
.long 4688,4920,250096,1229040
.long 808,1088,491520,1229824
.long 824,1096,491536,1229840
.long 840,1104,491552,1229856
.long 856,1112,491568,1229872
.long 2088,2368,491584,1229888
.long 2104,2376,491600,1229904
.long 2120,2384,491616,1229920
.long 2136,2392,491632,1229936
.long 3368,3648,491648,1229952
.long 3384,3656,491664,1229968
.long 3400,3664,491680,1229984
.long 3416,3672,491696,1230000
.long 4648,4928,491712,1230016
.long 4664,4936,491728,1230032
.long 4680,4944,491744,1230048
.long 4696,4952,491760,1230064
.long 864,1120,492544,1230848
.long 880,1136,492560,1230864
.long 896,1152,492576,1230880
.long 912,1168,492592,1230896
.long 2144,2400,492608,1230912
.long 2160,2416,492624,1230928
.long 2176,2432,492640,1230944
.long 2192,2448,492656,1230960
.long 3424,3680,492672,1230976
.long 3440,3696,492688,1230992
.long 3456,3712,492704,1231008
.long 3472,3728,492720,1231024
.long 4704,4960,492736,1231040
.long 4720,4976,492752,1231056
.long 4736,4992,492768,1231072
.long 4752,5008,492784,1231088
.long 872,1128,493568,1231872
.long 888,1144,493584,1231888
.long 904,1160,493600,1231904
.long 920,1176,493616,1231920
.long 2152,2408,493632,1231936
.long 2168,2424,493648,1231952
.long 2184,2440,493664,1231968
.long 2200,2456,493680,1231984
.long 3432,3688,493696,1232000
.long 3448,3704,493712,1232016
.long 3464,3720,493728,1232032
.long 3480,3736,493744,1232048
.long 4712,4968,493760,1232064
.long 4728,4984,493776,1232080
.long 4744,5000,493792,1232096
.long 4760,5016,493808,1232112
.long 928,1184,494592,1232896
.long 936,1200,494608,1232912
.long 944,1216,494624,1232928
.long 952,1232,494640,1232944
.long 2208,2464,494656,1232960
.long 2216,2480,494672,1232976
.long 2224,2496,494688,1232992
.long 2232,2512,494704,1233008
.long 3488,3744,494720,1233024
.long 3496,3760,494736,1233040
.long 3504,3776,494752,1233056
.long 3512,3792,494768,1233072
.long 4768,5024,494784,1233088
.long 4776,5040,494800,1233104
.long 4784,5056,494816,1233120
.long 4792,5072,494832,1233136
.long 960,1192,495616,1474560
.long 976,1208,495632,1474576
.long 992,1224,495648,1474592
.long 1008,1240,495664,1474608
.long 2240,2472,495680,1474624
.long 2256,2488,495696,1474640
.long 2272,2504,495712,1474656
.long 2288,2520,495728,1474672
.long 3520,3752,495744,1474688
.long 3536,3768,495760,1474704
.long 3552,3784,495776,1474720
.long 3568,3800,495792,1474736
.long 4800,5032,495808,1474752
.long 4816,5048,495824,1474768
.long 4832,5064,495840,1474784
.long 4848,5080,495856,1474800
.long 968,1248,737280,1475584
.long 984,1256,737296,1475600
.long 1000,1264,737312,1475616
.long 1016,1272,737328,1475632
.long 2248,2528,737344,1475648
.long 2264,2536,737360,1475664
.long 2280,2544,737376,1475680
.long 2296,2552,737392,1475696
.long 3528,3808,737408,1475712
.long 3544,3816,737424,1475728
.long 3560,3824,737440,1475744
.long 3576,3832,737456,1475760
.long 4808,5088,737472,1475776
.long 4824,5096,737488,1475792
.long 4840,5104,737504,1475808
.long 4856,5112,737520,1475824
.long 1476608,0,0,0
.long 1476624,1024,0,0
.long 1476640,2048,0,0
.long 1476656,3072,0,0
.long 1476672,4096,0,0
.long 1476688,5120,0,0
.long 1476704,6144,0,0
.long 1476720,7168,0,0
.long 1476736,8192,0,0
.long 1476752,9216,0,0
.long 1476768,10240,0,0
.long 1476784,11264,0,0
.long 1476800,12288,0,0
.long 1476816,13312,0,0
.long 1476832,14336,0,0
.long 1476848,15360,0,0
.long 1477632,16384,0,0
.long 1477648,17408,0,0
.long 1477664,18432,0,0
.long 1477680,19456,0,0
.long 1477696,20480,0,0
.long 1477712,21504,0,0
.long 1477728,22528,0,0
.long 1477744,23552,0,0
.long 1477760,24576,0,0
.long 1477776,25600,0,0
.long 1477792,26624,0,0
.long 1477808,27648,0,0
.long 1477824,28672,0,0
.long 1477840,29696,0,0
.long 1477856,30720,0,0
.long 1477872,31744,0,0
.long 1478656,128,0,0
.long 1478672,1152,0,0
.long 1478688,2176,0,0
.long 1478704,3200,0,0
.long 1478720,4224,0,0
.long 1478736,5248,0,0
.long 1478752,6272,0,0
.long 1478768,7296,0,0
.long 1478784,8320,0,0
.long 1478800,9344,0,0
.long 1478816,10368,0,0
.long 1478832,11392,0,0
.long 1478848,12416,0,0
.long 1478864,13440,0,0
.long 1478880,14464,0,0
.long 1478896,15488,0,0
.long 1720320,16512,0,0
.long 1720336,17536,0,0
.long 1720352,18560,0,0
.long 1720368,19584,0,0
.long 1720384,20608,0,0
.long 1720400,21632,0,0
.long 1720416,22656,0,0
.long 1720432,23680,0,0
.long 1720448,24704,0,0
.long 1720464,25728,0,0
.long 1720480,26752,0,0
.long 1720496,27776,0,0
.long 1720512,28800,0,0
.long 1720528,29824,0,0
.long 1720544,30848,0,0
.long 1720560,31872,0,0
.long 1721344,256,0,0
.long 1721360,1280,0,0
.long 1721376,2304,0,0
.long 1721392,3328,0,0
.long 1721408,4352,0,0
.long 1721424,5376,0,0
.long 1721440,6400,0,0
.long 1721456,7424,0,0
.long 1721472,8448,0,0
.long 1721488,9472,0,0
.long 1721504,10496,0,0
.long 1721520,11520,0,0
.long 1721536,12544,0,0
.long 1721552,13568,0,0
.long 1721568,14592,0,0
.long 1721584,15616,0,0
.long 1722368,16640,0,0
.long 1722384,17664,0,0
.long 1722400,18688,0,0
.long 1722416,19712,0,0
.long 1722432,20736,0,0
.long 1722448,21760,0,0
.long 1722464,22784,0,0
.long 1722480,23808,0,0
.long 1722496,24832,0,0
.long 1722512,25856,0,0
.long 1722528,26880,0,0
.long 1722544,27904,0,0
.long 1722560,28928,0,0
.long 1722576,29952,0,0
.long 1722592,30976,0,0
.long 1722608,32000,0,0
.long 1723392,384,0,0
.long 1723408,1408,0,0
.long 1723424,2432,0,0
.long 1723440,3456,0,0
.long 1723456,4480,0,0
.long 1723472,5504,0,0
.long 1723488,6528,0,0
.long 1723504,7552,0,0
.long 1723520,8576,0,0
.long 1723536,9600,0,0
.long 1723552,10624,0,0
.long 1723568,11648,0,0
.long 1723584,12672,0,0
.long 1723600,13696,0,0
.long 1723616,14720,0,0
.long 1723632,15744,0,0
.long 1724416,16768,0,0
.long 1724432,17792,0,0
.long 1724448,18816,0,0
.long 1724464,19840,0,0
.long 1724480,20864,0,0
.long 1724496,21888,0,0
.long 1724512,22912,0,0
.long 1724528,23936,0,0
.long 1724544,24960,0,0
.long 1724560,25984,0,0
.long 1724576,27008,0,0
.long 1724592,28032,0,0
.long 1724608,29056,0,0
.long 1724624,30080,0,0
.long 1724640,31104,0,0
.long 1724656,32128,0,0
.long 1476608,512,0,0
.long 1476624,1536,0,0
.long 1476640,2560,0,0
.long 1476656,3584,0,0
.long 1476672,4608,0,0
.long 1476688,5632,0,0
.long 1476704,6656,0,0
.long 1476720,7680,0,0
.long 1476736,8704,0,0
.long 1476752,9728,0,0
.long 1476768,10752,0,0
.long 1476784,11776,0,0
.long 1476800,12800,0,0
.long 1476816,13824,0,0
.long 1476832,14848,0,0
.long 1476848,15872,0,0
.long 1477632,16896,0,0
.long 1477648,17920,0,0
.long 1477664,18944,0,0
.long 1477680,19968,0,0
.long 1477696,20992,0,0
.long 1477712,22016,0,0
.long 1477728,23040,0,0
.long 1477744,24064,0,0
.long 1477760,25088,0,0
.long 1477776,26112,0,0
.long 1477792,27136,0,0
.long 1477808,28160,0,0
.long 1477824,29184,0,0
.long 1477840,30208,0,0
.long 1477856,31232,0,0
.long 1477872,32256,0,0
.long 1478656,640,0,0
.long 1478672,1664,0,0
.long 1478688,2688,0,0
.long 1478704,3712,0,0
.long 1478720,4736,0,0
.long 1478736,5760,0,0
.long 1478752,6784,0,0
.long 1478768,7808,0,0
.long 1478784,8832,0,0
.long 1478800,9856,0,0
.long 1478816,10880,0,0
.long 1478832,11904,0,0
.long 1478848,12928,0,0
.long 1478864,13952,0,0
.long 1478880,14976,0,0
.long 1478896,16000,0,0
.long 1720320,17024,0,0
.long 1720336,18048,0,0
.long 1720352,19072,0,0
.long 1720368,20096,0,0
.long 1720384,21120,0,0
.long 1720400,22144,0,0
.long 1720416,23168,0,0
.long 1720432,24192,0,0
.long 1720448,25216,0,0
.long 1720464,26240,0,0
.long 1720480,27264,0,0
.long 1720496,28288,0,0
.long 1720512,29312,0,0
.long 1720528,30336,0,0
.long 1720544,31360,0,0
.long 1720560,32384,0,0
.long 1721344,768,0,0
.long 1721360,1792,0,0
.long 1721376,2816,0,0
.long 1721392,3840,0,0
.long 1721408,4864,0,0
.long 1721424,5888,0,0
.long 1721440,6912,0,0
.long 1721456,7936,0,0
.long 1721472,8960,0,0
.long 1721488,9984,0,0
.long 1721504,11008,0,0
.long 1721520,12032,0,0
.long 1721536,13056,0,0
.long 1721552,14080,0,0
.long 1721568,15104,0,0
.long 1721584,16128,0,0
.long 1722368,17152,0,0
.long 1722384,18176,0,0
.long 1722400,19200,0,0
.long 1722416,20224,0,0
.long 1722432,21248,0,0
.long 1722448,22272,0,0
.long 1722464,23296,0,0
.long 1722480,24320,0,0
.long 1722496,25344,0,0
.long 1722512,26368,0,0
.long 1722528,27392,0,0
.long 1722544,28416,0,0
.long 1722560,29440,0,0
.long 1722576,30464,0,0
.long 1722592,31488,0,0
.long 1722608,32512,0,0
.long 1723392,896,0,0
.long 1723408,1920,0,0
.long 1723424,2944,0,0
.long 1723440,3968,0,0
.long 1723456,4992,0,0
.long 1723472,6016,0,0
.long 1723488,7040,0,0
.long 1723504,8064,0,0
.long 1723520,9088,0,0
.long 1723536,10112,0,0
.long 1723552,11136,0,0
.long 1723568,12160,0,0
.long 1723584,13184,0,0
.long 1723600,14208,0,0
.long 1723616,15232,0,0
.long 1723632,16256,0,0
.long 1724416,17280,0,0
.long 1724432,18304,0,0
.long 1724448,19328,0,0
.long 1724464,20352,0,0
.long 1724480,21376,0,0
.long 1724496,22400,0,0
.long 1724512,23424,0,0
.long 1724528,24448,0,0
.long 1724544,25472,0,0
.long 1724560,26496,0,0
.long 1724576,27520,0,0
.long 1724592,28544,0,0
.long 1724608,29568,0,0
.long 1724624,30592,0,0
.long 1724640,31616,0,0
.long 1724656,32640,0,0
L_table_end:
.section .rodata,"a"
.p2align 6
.amdhsa_kernel sequential_preLN__ssm_conv_s4__dense_activation_gelu__prompt_kernel
  .amdhsa_next_free_vgpr 512
  .amdhsa_next_free_sgpr 102
  .amdhsa_accum_offset 256
  .amdhsa_group_segment_fixed_size 0
  .amdhsa_kernarg_size 136
  .amdhsa_user_sgpr_count 2
  .amdhsa_user_sgpr_kernarg_segment_ptr 1
  .amdhsa_system_sgpr_workgroup_id_x 1
  .amdhsa_float_denorm_mode_32 3
.end_amdhsa_kernel
```
